```python
import torch

def _softmax(x, axis=-1):
    return torch.softmax(x, dim=axis)
def _gelu(x):
    return torch.nn.functional.gelu(x, approximate="tanh")
def _silu(x):
    return torch.nn.functional.silu(x)
def _sigmoid(x):
    return torch.sigmoid(x)
def _layernorm(x, axis=-1, eps=1e-5):
    m = x.mean(dim=axis, keepdim=True)
    v = x.var(dim=axis, keepdim=True, unbiased=False)
    return (x - m) / torch.sqrt(v + eps)
def _scatter_add(tgt, idx, src, axis=0):
    return tgt.clone().index_add_(axis, idx, src)
def _segment_sum(src, seg, n):
    out = torch.zeros((n,) + src.shape[1:], dtype=src.dtype)
    return out.index_add_(0, seg, src)
def _pad(x, pw):
    flat = tuple(v for pair in reversed(pw) for v in pair)
    return torch.nn.functional.pad(x, flat)

kernel_name = 'sequential_preLN__sliding_local_dilated__dense_activation_silu__prompt'

def setup_inputs():

    _w = (lambda a: (lambda t: t.to(torch.bfloat16) if t.is_floating_point() else t)(torch.as_tensor(a)))
    def _A_setup():
        B, S, D = 1, 2048, 640
        return {
            "x": _w((lambda *s: torch.randn(*s, dtype=torch.bfloat16) * 0.05)(B, S, D)),
            "wqkv": _w((lambda *s: torch.randn(*s, dtype=torch.bfloat16) * 0.05)(D, 3 * D)),
            "wo": _w((lambda *s: torch.randn(*s, dtype=torch.bfloat16) * 0.05)(D, D)),
        }
    _A_in = _A_setup()

    def _B_setup():
        B, S, D, F = 1, 2048, 640, 1728
        return {
            "x": _w((lambda *s: torch.randn(*s, dtype=torch.bfloat16) * 0.05)(B, S, D)),
            "w1": _w((lambda *s: torch.randn(*s, dtype=torch.bfloat16) * 3.2)(D, F) * (D ** -0.5)),
            "w2": _w((lambda *s: torch.randn(*s, dtype=torch.bfloat16) * 0.4)(F, D) * (F ** -0.5)),
        }
    _B_in = _B_setup()

    return {
        "A_x": _A_in["x"],
        "A_wqkv": _A_in["wqkv"],
        "A_wo": _A_in["wo"],
        "B_x": _B_in["x"],
        "B_w1": _B_in["w1"],
        "B_w2": _B_in["w2"],
    }

def reference(A_x, A_wqkv, A_wo, B_x, B_w1, B_w2):
    def _A_ref(x, wqkv, wo):
        B, S, D = x.shape
        H = 32; Dh = D // H
        W, dil = 8, 2
        qkv = (lambda x, *d: x.permute(*d))((x @ wqkv).reshape(B, S, 3, H, Dh), 2, 0, 3, 1, 4)
        q, k, v = qkv[0], qkv[1], qkv[2]
        scale = Dh ** -0.5
        pos = torch.arange(S)
        off = torch.arange(W) * dil
        idx = pos[:, None] - off[None, :]
        mask = idx >= 0
        idx_c = torch.where(mask, idx, 0).reshape(-1)
        kg = k[:, :, idx_c, :].reshape(B, H, S, W, Dh)
        vg = v[:, :, idx_c, :].reshape(B, H, S, W, Dh)
        logits = torch.einsum("bhsd,bhswd->bhsw", q, kg) * scale
        logits = torch.where(mask[None, None, :, :], logits, -1e9)
        attn = _softmax(logits, axis=-1)
        o = torch.einsum("bhsw,bhswd->bhsd", attn, vg)
        return (lambda x, *d: x.permute(*d))(o, 0, 2, 1, 3).reshape(B, S, D) @ wo

    def _B_ref(x, w1, w2):
        h = torch.einsum("bsd,df->bsf", x, w1)
        h = _silu(h)
        out = torch.einsum("bsf,fd->bsd", h, w2)
        return out

    x = A_x
    h = x + _A_ref(_layernorm(x, axis=-1), A_wqkv, A_wo)
    h2 = h + _B_ref(_layernorm(h, axis=-1), B_w1, B_w2)
    return h2
```

```asm
; @launch grid=(256,1,1) block=(256,1,1) lds=163840
.amdgcn_target "amdgcn-amd-amdhsa--gfx950"
.text
.globl sequential_preLN__sliding_local_dilated__dense_activation_silu__prompt_kernel
.p2align 8
.type sequential_preLN__sliding_local_dilated__dense_activation_silu__prompt_kernel,@function
sequential_preLN__sliding_local_dilated__dense_activation_silu__prompt_kernel:
Lstart:
s_cmp_ge_u32 s2, 256
s_cbranch_scc1 Lend
s_load_dwordx4 s[8:11], s[0:1], 0
s_load_dwordx2 s[32:33], s[0:1], 64
v_lshrrev_b32 v1, 6, v0
s_lshr_b32 s5, s2, 3
v_and_b32 v0, 63, v0
v_readfirstlane_b32 s6, v1
s_and_b32 s4, s2, 7
s_cmp_ge_u32 s5, 30
s_cbranch_scc1 Lhelp
v_lshrrev_b32 v178, 4, v0
s_lshl_b32 s47, s6, 4
v_and_b32 v179, 15, v0
v_add_u32 v177, s47, v178
v_lshlrev_b32 v180, 2, v178
v_mul_u32_u24 v177, 3840, v177
v_xor_b32 v179, v179, v180
s_lshr_b32 s40, s5, 1
v_lshl_add_u32 v156, v179, 4, v177
s_lshl_b32 s43, s40, 8
s_lshl_b32 s46, s6, 12
v_add_u32 v157, 14336, v156
v_add_u32 v158, 28672, v156
v_add_u32 v159, 43008, v156
s_mov_b32 s14, 2457600
s_mov_b32 s15, 0x20000
s_waitcnt lgkmcnt(0)
s_mov_b64 s[12:13], s[10:11]
s_mov_b32 s10, 2621440
s_mov_b32 s11, 0x20000
s_mov_b32 s45, s4
s_add_u32 m0, s46, 16384
s_mul_i32 s54, s45, 245760
s_add_u32 s54, s54, s43
buffer_load_dwordx4 v156, s[12:15], s54 offen lds
buffer_load_dwordx4 v157, s[12:15], s54 offen offset:1024 lds
buffer_load_dwordx4 v158, s[12:15], s54 offen offset:2048 lds
buffer_load_dwordx4 v159, s[12:15], s54 offen offset:3072 lds
v_lshrrev_b32 v176, 3, v0
s_lshl_b32 s47, s6, 5
v_and_b32 v179, 7, v0
v_add_u32 v177, s47, v176
v_xor_b32 v179, v179, v178
v_mul_u32_u24 v177, 1280, v177
s_and_b32 s41, s5, 1
v_lshl_add_u32 v152, v179, 4, v177
s_lshl1_add_u32 s42, s4, s41
v_xor_b32 v180, 64, v152
s_mul_i32 s42, s42, 163840
v_add_u32 v153, 9216, v180
v_add_u32 v154, 18432, v152
v_add_u32 v155, 27648, v180
s_lshl_b32 s51, s45, 7
s_add_u32 m0, s46, 0
s_add_u32 s52, s51, s42
buffer_load_dwordx4 v152, s[8:11], s52 offen lds
buffer_load_dwordx4 v153, s[8:11], s52 offen offset:1024 lds
buffer_load_dwordx4 v154, s[8:11], s52 offen offset:2048 lds
s_and_b32 s47, s6, 1
s_lshl_b32 s48, s47, 3
v_add_u32 v177, s48, v176
v_mul_u32_u24 v177, 1280, v177
v_lshl_add_u32 v160, v179, 4, v177
s_lshl_b32 s47, s47, 6
v_xor_b32 v160, s47, v160
s_sub_u32 s44, s42, 20480
s_cmp_eq_u32 s4, 0
s_cselect_b32 s44, 2130706432, s44
s_lshl_b32 s49, s6, 10
s_lshr_b32 s47, s6, 1
s_or_b32 s50, s47, s41
s_lshl_b32 s51, s45, 7
s_cmp_lg_u32 s50, 0
s_cbranch_scc1 Lh_1
s_add_u32 m0, s49, 131072
s_add_u32 s53, s51, s44
buffer_load_dwordx4 v160, s[8:11], s53 offen lds
Lh_1:
s_mov_b32 m0, s46
s_nop 0
buffer_load_dwordx4 v155, s[8:11], s52 offen offset:3072 lds
s_getpc_b64 s[52:53]
Lpc0:
s_sub_u32 s52, s52, Lpc0-Lstart
s_subb_u32 s53, s53, 0
v_lshlrev_b32 v22, 7, v0
s_lshl_b32 s54, s5, 11
s_add_u32 s52, s52, s54
s_addc_u32 s53, s53, 0
s_sub_u32 s54, Lendcode-Lstart-4, s54
s_min_i32 s54, s54, 2047
s_cmp_lg_u32 s6, 0
s_cselect_b32 s54, -1, s54
v_cmp_ge_i32 vcc, s54, v22
s_and_saveexec_b64 s[54:55], vcc
s_cbranch_execz Lnopf0
global_load_dword v252, v22, s[52:53]
Lnopf0:
s_mov_b64 exec, -1
s_load_dwordx2 s[16:17], s[0:1], 16
s_load_dwordx4 s[20:23], s[0:1], 32
s_load_dwordx2 s[28:29], s[0:1], 48
s_lshl_b32 s58, s6, 5
s_add_u32 s58, s58, s5
s_lshl_b32 s59, s4, 6
s_add_u32 s59, s59, s58
s_sub_u32 s59, s59, 4
v_lshrrev_b32 v3, 4, v0
v_mul_u32_u24 v2, 1280, v3
v_and_b32 v4, 15, v0
v_lshl_add_u32 v2, v4, 4, v2
s_mul_i32 s3, s59, 5120
s_cmp_lt_i32 s59, 0
s_cselect_b32 s59, 2130706432, s3
s_lshl_b32 s3, s4, 22
s_mov_b32 s34, 4194304
s_mov_b32 s35, 0x20000
s_add_u32 s32, s32, s3
s_addc_u32 s33, s33, 0
s_cmp_ge_u32 s58, 68
s_cbranch_scc1 Ls_2
buffer_load_dwordx4 v[4:7], v2, s[8:11], s59 offen offset:0
buffer_load_dwordx4 v[8:11], v2, s[8:11], s59 offen offset:256
buffer_load_dwordx4 v[12:15], v2, s[8:11], s59 offen offset:512
buffer_load_dwordx4 v[16:19], v2, s[8:11], s59 offen offset:768
buffer_load_dwordx4 v[20:23], v2, s[8:11], s59 offen offset:1024
Ls_2:
s_mov_b32 s3, 1736704
v_mov_b32 v254, 0
buffer_load_dword v255, v254, s[32:35], s3 offen sc1
s_waitcnt lgkmcnt(0)
s_mov_b64 s[24:25], s[22:23]
s_mov_b32 s18, 819200
s_mov_b32 s19, 0x20000
s_mov_b32 s22, 2211840
s_mov_b32 s23, 0x20000
s_mov_b32 s26, 2211840
s_mov_b32 s27, 0x20000
s_mov_b32 s30, 2621440
s_mov_b32 s31, 0x20000
v_and_b32 v176, 31, v0
v_lshrrev_b32 v177, 5, v0
v_bfe_u32 v178, v0, 1, 3
v_xor_b32 v178, v177, v178
v_lshlrev_b32 v178, 4, v178
v_lshl_add_u32 v162, v176, 7, v178
v_bfe_u32 v178, v0, 2, 3
v_xor_b32 v178, v177, v178
v_lshlrev_b32 v178, 4, v178
v_lshrrev_b32 v179, 1, v176
v_lshl_add_u32 v178, v179, 7, v178
v_add_u32 v178, 131072, v178
v_lshlrev_b32 v222, 4, v176
v_lshlrev_b32 v223, 4, v179
v_mul_u32_u24 v177, 4352, v177
v_add_u32 v220, v222, v177
v_add_u32 v221, 8704, v220
v_add_u32 v224, v223, v177
v_lshrrev_b32 v226, 4, v0
v_mul_u32_u24 v227, 4352, v226
v_and_b32 v226, 15, v0
v_lshl_add_u32 v226, v226, 7, v227
s_mov_b32 vcc_lo, 0x55555555
s_mov_b32 vcc_hi, 0x55555555
v_mov_b32 v179, 133120
v_xor_b32 v163, 32, v162
v_xor_b32 v164, 64, v162
v_xor_b32 v165, 96, v162
v_xor_b32 v172, 0, v178
v_cndmask_b32 v172, v172, v179, vcc
v_xor_b32 v173, 32, v178
v_cndmask_b32 v173, v173, v179, vcc
v_xor_b32 v174, 64, v178
v_cndmask_b32 v174, v174, v179, vcc
v_xor_b32 v175, 96, v178
v_cndmask_b32 v175, v175, v179, vcc
v_add_u32 v166, 0x10000, v162
v_add_u32 v167, 0x10000, v163
v_add_u32 v168, 0x10000, v164
v_add_u32 v169, 0x10000, v165
v_and_b32 v170, 16, v0
v_lshlrev_b32 v170, 1, v170
v_and_b32 v176, 1, v0
v_lshl_or_b32 v170, v176, 4, v170
v_and_b32 v176, 2, v0
v_lshl_or_b32 v170, v176, 2, v170
v_lshrrev_b32 v176, 5, v0
v_bfe_u32 v177, v0, 2, 2
v_lshl_or_b32 v176, v176, 3, v177
v_lshl_add_u32 v170, v176, 8, v170
v_xor_b32 v177, s6, v177
v_lshl_add_u32 v170, v177, 6, v170
v_add_u32 v171, 0x10000, v170
v_mul_u32_u24 v176, 2176, v0
v_add_u32 v176, 133120, v176
v_mov_b32 v180, 0x3f803f80
v_mov_b32 v181, 0x3f803f80
v_mov_b32 v182, 0x3f803f80
v_mov_b32 v183, 0x3f803f80
s_mov_b64 exec, 0x3ff
ds_write_b128 v176, v[180:183]
s_mov_b64 exec, -1
s_mul_i32 s98, s5, 205
s_lshr_b32 s98, s98, 11
s_mul_i32 s97, s98, 10
s_sub_u32 s97, s5, s97
s_cmp_ge_u32 s5, 14
s_cselect_b32 s100, 1, 0
s_mul_i32 s99, s100, 14
s_sub_u32 s99, s5, s99
s_lshl_b32 s99, s99, 2
s_add_u32 s99, s99, s6
s_lshl_b32 s93, s99, 6
s_cmp_ge_u32 s99, 54
s_cselect_b32 s93, 2130706432, s93
s_mul_i32 s3, s100, 0
s_sub_u32 s94, s93, s3
s_add_u32 s93, s93, s3
s_sub_u32 s3, s99, 56
s_lshl_b32 s3, s3, 7
s_cmp_ge_u32 s5, 28
s_cselect_b32 s94, s3, s94
s_lshl_b32 s3, s97, 7
s_mul_i32 s95, s6, 81920
s_add_u32 s95, s95, s3
s_cmp_ge_u32 s5, 20
s_cselect_b32 s95, 2130706432, s95
s_mul_i32 s96, s6, 552960
s_add_u32 s96, s96, s3
v_lshrrev_b32 v176, 2, v0
v_mul_u32_u24 v176, 3456, v176
v_and_b32 v177, 3, v0
v_lshl_add_u32 v240, v177, 4, v176
v_add_u32 v241, 54272, v240
v_add_u32 v242, 108544, v240
v_add_u32 v243, 162816, v240
v_lshrrev_b32 v176, 3, v0
v_mul_u32_u24 v244, 1280, v176
v_and_b32 v177, 7, v0
v_bfe_u32 v176, v0, 4, 1
v_lshlrev_b32 v176, 2, v176
v_xor_b32 v177, v177, v176
v_lshl_add_u32 v244, v177, 4, v244
v_add_u32 v245, 9216, v244
v_add_u32 v246, 18432, v244
v_add_u32 v247, 27648, v244
v_and_b32 v248, 16, v0
v_lshlrev_b32 v248, 1, v248
v_and_b32 v176, 1, v0
v_lshl_or_b32 v248, v176, 4, v248
v_and_b32 v176, 2, v0
v_lshl_or_b32 v248, v176, 2, v248
v_lshrrev_b32 v176, 5, v0
v_bfe_u32 v177, v0, 2, 2
v_lshl_or_b32 v176, v176, 3, v177
v_lshl_add_u32 v249, v176, 7, v248
v_lshl_add_u32 v248, v176, 6, v248
v_lshrrev_b32 v177, 1, v177
v_lshl_add_u32 v249, v177, 6, v249
s_add_u32 s45, s45, 1
s_add_u32 m0, s46, 49152
s_mul_i32 s54, s45, 245760
s_add_u32 s54, s54, s43
buffer_load_dwordx4 v156, s[12:15], s54 offen lds
buffer_load_dwordx4 v157, s[12:15], s54 offen offset:1024 lds
buffer_load_dwordx4 v158, s[12:15], s54 offen offset:2048 lds
buffer_load_dwordx4 v159, s[12:15], s54 offen offset:3072 lds
s_lshl_b32 s51, s45, 7
s_cmp_lg_u32 s50, 0
s_cbranch_scc1 Lh_3
s_add_u32 m0, s49, 133248
s_add_u32 s53, s51, s44
buffer_load_dwordx4 v160, s[8:11], s53 offen lds
Lh_3:
s_add_u32 m0, s46, 32768
s_add_u32 s52, s51, s42
buffer_load_dwordx4 v152, s[8:11], s52 offen lds
buffer_load_dwordx4 v153, s[8:11], s52 offen offset:1024 lds
buffer_load_dwordx4 v154, s[8:11], s52 offen offset:2048 lds
buffer_load_dwordx4 v155, s[8:11], s52 offen offset:3072 lds
s_waitcnt vmcnt(9)
s_waitcnt lgkmcnt(0)
s_barrier
ds_read_b64_tr_b16 v[144:145], v170 offset:16384
ds_read_b64_tr_b16 v[146:147], v170 offset:17408
ds_read_b128 v[104:107], v162 offset:0
ds_read_b128 v[108:111], v162 offset:4096
ds_read_b128 v[112:115], v162 offset:8192
ds_read_b128 v[116:119], v162 offset:12288
ds_read_b128 v[120:123], v172 offset:0
s_waitcnt lgkmcnt(4)
v_mfma_f32_32x32x16_bf16 v[24:39], v[144:147], v[104:107], 0
ds_read_b64_tr_b16 v[148:149], v170 offset:20480
ds_read_b64_tr_b16 v[150:151], v170 offset:21504
ds_read_b128 v[124:127], v163 offset:0
s_waitcnt lgkmcnt(6)
v_mfma_f32_32x32x16_bf16 v[40:55], v[144:147], v[108:111], 0
ds_read_b128 v[128:131], v163 offset:4096
ds_read_b128 v[132:135], v163 offset:8192
s_waitcnt lgkmcnt(7)
v_mfma_f32_32x32x16_bf16 v[56:71], v[144:147], v[112:115], 0
ds_read_b128 v[136:139], v163 offset:12288
ds_read_b128 v[140:143], v173 offset:0
s_waitcnt lgkmcnt(8)
v_mfma_f32_32x32x16_bf16 v[72:87], v[144:147], v[116:119], 0
s_add_u32 s45, s45, 1
s_add_u32 m0, s46, 81920
s_mul_i32 s54, s45, 245760
s_add_u32 s54, s54, s43
buffer_load_dwordx4 v156, s[12:15], s54 offen lds
buffer_load_dwordx4 v157, s[12:15], s54 offen offset:1024 lds
s_waitcnt lgkmcnt(7)
v_mfma_f32_32x32x16_bf16 v[88:103], v[144:147], v[120:123], 0
buffer_load_dwordx4 v158, s[12:15], s54 offen offset:2048 lds
buffer_load_dwordx4 v159, s[12:15], s54 offen offset:3072 lds
s_waitcnt lgkmcnt(4)
v_mfma_f32_32x32x16_bf16 v[24:39], v[148:151], v[124:127], v[24:39]
ds_read_b64_tr_b16 v[144:145], v170 offset:24576
ds_read_b64_tr_b16 v[146:147], v170 offset:25600
ds_read_b128 v[104:107], v164 offset:0
s_waitcnt lgkmcnt(6)
v_mfma_f32_32x32x16_bf16 v[40:55], v[148:151], v[128:131], v[40:55]
ds_read_b128 v[108:111], v164 offset:4096
ds_read_b128 v[112:115], v164 offset:8192
s_waitcnt lgkmcnt(7)
v_mfma_f32_32x32x16_bf16 v[56:71], v[148:151], v[132:135], v[56:71]
ds_read_b128 v[116:119], v164 offset:12288
ds_read_b128 v[120:123], v174 offset:0
s_waitcnt lgkmcnt(8)
v_mfma_f32_32x32x16_bf16 v[72:87], v[148:151], v[136:139], v[72:87]
s_lshl_b32 s51, s45, 7
s_cmp_lg_u32 s50, 0
s_cbranch_scc1 Lh_4
s_add_u32 m0, s49, 135424
s_add_u32 s53, s51, s44
buffer_load_dwordx4 v160, s[8:11], s53 offen lds
Lh_4:
s_add_u32 m0, s46, 65536
s_add_u32 s52, s51, s42
buffer_load_dwordx4 v152, s[8:11], s52 offen lds
s_waitcnt lgkmcnt(7)
v_mfma_f32_32x32x16_bf16 v[88:103], v[148:151], v[140:143], v[88:103]
buffer_load_dwordx4 v153, s[8:11], s52 offen offset:1024 lds
buffer_load_dwordx4 v154, s[8:11], s52 offen offset:2048 lds
s_waitcnt lgkmcnt(4)
v_mfma_f32_32x32x16_bf16 v[24:39], v[144:147], v[104:107], v[24:39]
ds_read_b64_tr_b16 v[148:149], v170 offset:28672
ds_read_b64_tr_b16 v[150:151], v170 offset:29696
s_waitcnt lgkmcnt(5)
v_mfma_f32_32x32x16_bf16 v[40:55], v[144:147], v[108:111], v[40:55]
ds_read_b128 v[124:127], v165 offset:0
ds_read_b128 v[128:131], v165 offset:4096
s_waitcnt lgkmcnt(6)
v_mfma_f32_32x32x16_bf16 v[56:71], v[144:147], v[112:115], v[56:71]
ds_read_b128 v[132:135], v165 offset:8192
ds_read_b128 v[136:139], v165 offset:12288
s_waitcnt lgkmcnt(7)
v_mfma_f32_32x32x16_bf16 v[72:87], v[144:147], v[116:119], v[72:87]
ds_read_b128 v[140:143], v175 offset:0
buffer_load_dwordx4 v155, s[8:11], s52 offen offset:3072 lds
s_waitcnt lgkmcnt(7)
v_mfma_f32_32x32x16_bf16 v[88:103], v[144:147], v[120:123], v[88:103]
s_add_u32 s45, s45, 1
s_cmp_eq_u32 s45, 10
s_cselect_b32 s45, 0, s45
s_add_u32 m0, s46, 114688
s_mul_i32 s54, s45, 245760
s_add_u32 s54, s54, s43
buffer_load_dwordx4 v156, s[12:15], s54 offen lds
buffer_load_dwordx4 v157, s[12:15], s54 offen offset:1024 lds
s_waitcnt lgkmcnt(4)
v_mfma_f32_32x32x16_bf16 v[24:39], v[148:151], v[124:127], v[24:39]
s_mov_b32 s91, 0x100000
s_waitcnt vmcnt(18)
v_readfirstlane_b32 s7, v255
s_add_u32 s7, s7, 1
s_cmp_ge_u32 s58, 68
s_cbranch_scc1 Ls_5
s_mov_b32 s59, 0x3f803f80
v_dot2_f32_bf16 v204, v4, s59, 0
v_dot2_f32_bf16 v205, v4, v4, 0
v_dot2_f32_bf16 v204, v5, s59, v204
v_dot2_f32_bf16 v205, v5, v5, v205
v_dot2_f32_bf16 v204, v6, s59, v204
v_dot2_f32_bf16 v205, v6, v6, v205
v_dot2_f32_bf16 v204, v7, s59, v204
v_dot2_f32_bf16 v205, v7, v7, v205
v_dot2_f32_bf16 v204, v8, s59, v204
v_dot2_f32_bf16 v205, v8, v8, v205
v_dot2_f32_bf16 v204, v9, s59, v204
v_dot2_f32_bf16 v205, v9, v9, v205
v_dot2_f32_bf16 v204, v10, s59, v204
v_dot2_f32_bf16 v205, v10, v10, v205
v_dot2_f32_bf16 v204, v11, s59, v204
v_dot2_f32_bf16 v205, v11, v11, v205
v_dot2_f32_bf16 v204, v12, s59, v204
v_dot2_f32_bf16 v205, v12, v12, v205
v_dot2_f32_bf16 v204, v13, s59, v204
v_dot2_f32_bf16 v205, v13, v13, v205
v_dot2_f32_bf16 v204, v14, s59, v204
v_dot2_f32_bf16 v205, v14, v14, v205
v_dot2_f32_bf16 v204, v15, s59, v204
v_dot2_f32_bf16 v205, v15, v15, v205
v_dot2_f32_bf16 v204, v16, s59, v204
v_dot2_f32_bf16 v205, v16, v16, v205
v_dot2_f32_bf16 v204, v17, s59, v204
v_dot2_f32_bf16 v205, v17, v17, v205
v_dot2_f32_bf16 v204, v18, s59, v204
v_dot2_f32_bf16 v205, v18, v18, v205
v_dot2_f32_bf16 v204, v19, s59, v204
v_dot2_f32_bf16 v205, v19, v19, v205
v_dot2_f32_bf16 v204, v20, s59, v204
v_dot2_f32_bf16 v205, v20, v20, v205
v_dot2_f32_bf16 v204, v21, s59, v204
v_dot2_f32_bf16 v205, v21, v21, v205
v_dot2_f32_bf16 v204, v22, s59, v204
v_dot2_f32_bf16 v205, v22, v22, v205
v_dot2_f32_bf16 v204, v23, s59, v204
v_dot2_f32_bf16 v205, v23, v23, v205
s_nop 1
v_add_f32_dpp v204, v204, v204 quad_perm:[1,0,3,2] row_mask:0xf bank_mask:0xf
v_add_f32_dpp v205, v205, v205 quad_perm:[1,0,3,2] row_mask:0xf bank_mask:0xf
s_nop 0
v_add_f32_dpp v204, v204, v204 quad_perm:[2,3,0,1] row_mask:0xf bank_mask:0xf
v_add_f32_dpp v205, v205, v205 quad_perm:[2,3,0,1] row_mask:0xf bank_mask:0xf
s_nop 0
v_add_f32_dpp v204, v204, v204 row_half_mirror row_mask:0xf bank_mask:0xf
v_add_f32_dpp v205, v205, v205 row_half_mirror row_mask:0xf bank_mask:0xf
s_nop 0
v_add_f32_dpp v204, v204, v204 row_mirror row_mask:0xf bank_mask:0xf
v_add_f32_dpp v205, v205, v205 row_mirror row_mask:0xf bank_mask:0xf
v_mul_f32 v204, 0xbacccccd, v204
v_mul_f32 v205, 0x3acccccd, v205
v_fma_f32 v205, -v204, v204, v205
v_max_f32 v205, 0, v205
v_add_f32 v205, 0x3727c5ac, v205
v_rsq_f32 v208, v205
v_mov_b32 v210, s7
s_getreg_b32 s59, hwreg(HW_REG_XCC_ID, 0, 4)
v_mov_b32 v211, s59
v_mul_f32 v209, v204, v208
v_lshlrev_b32 v3, 4, v3
s_lshl_b32 s58, s58, 6
s_add_u32 s58, s58, 1703936
s_mov_b32 exec_lo, 0x00010001
s_mov_b32 exec_hi, 0x00010001
buffer_store_dwordx4 v[208:211], v3, s[32:35], s58 offen sc1
s_mov_b64 exec, -1
Ls_5:
s_lshl_b32 s55, s41, 11
s_lshl_b32 s58, s40, 2
s_add_u32 s58, s58, s6
s_mul_i32 s58, s58, 17408
s_add_u32 s59, s58, s55
s_add_u32 s59, s59, 256
s_add_u32 s55, s55, 1704192
s_lshl_b32 s47, s6, 13
s_waitcnt vmcnt(10)
s_waitcnt lgkmcnt(0)
s_barrier
ds_read_b64_tr_b16 v[144:145], v170 offset:49152
ds_read_b64_tr_b16 v[146:147], v170 offset:50176
v_mfma_f32_32x32x16_bf16 v[40:55], v[148:151], v[128:131], v[40:55]
ds_read_b128 v[104:107], v162 offset:32768
ds_read_b128 v[108:111], v162 offset:36864
v_mfma_f32_32x32x16_bf16 v[56:71], v[148:151], v[132:135], v[56:71]
ds_read_b128 v[112:115], v162 offset:40960
ds_read_b128 v[116:119], v162 offset:45056
ds_read_b128 v[120:123], v172 offset:2176
v_mfma_f32_32x32x16_bf16 v[72:87], v[148:151], v[136:139], v[72:87]
buffer_load_dwordx4 v158, s[12:15], s54 offen offset:2048 lds
buffer_load_dwordx4 v159, s[12:15], s54 offen offset:3072 lds
v_mfma_f32_32x32x16_bf16 v[88:103], v[148:151], v[140:143], v[88:103]
s_lshl_b32 s51, s45, 7
s_cmp_lg_u32 s50, 0
s_cbranch_scc1 Lh_6
s_add_u32 m0, s49, 137600
s_add_u32 s53, s51, s44
buffer_load_dwordx4 v160, s[8:11], s53 offen lds
Lh_6:
s_add_u32 m0, s46, 98304
s_add_u32 s52, s51, s42
buffer_load_dwordx4 v152, s[8:11], s52 offen lds
s_waitcnt lgkmcnt(4)
v_mfma_f32_32x32x16_bf16 v[24:39], v[144:147], v[104:107], v[24:39]
ds_read_b64_tr_b16 v[148:149], v170 offset:53248
ds_read_b64_tr_b16 v[150:151], v170 offset:54272
s_waitcnt lgkmcnt(5)
v_mfma_f32_32x32x16_bf16 v[40:55], v[144:147], v[108:111], v[40:55]
ds_read_b128 v[124:127], v163 offset:32768
ds_read_b128 v[128:131], v163 offset:36864
s_waitcnt lgkmcnt(6)
v_mfma_f32_32x32x16_bf16 v[56:71], v[144:147], v[112:115], v[56:71]
ds_read_b128 v[132:135], v163 offset:40960
ds_read_b128 v[136:139], v163 offset:45056
s_waitcnt lgkmcnt(7)
v_mfma_f32_32x32x16_bf16 v[72:87], v[144:147], v[116:119], v[72:87]
ds_read_b128 v[140:143], v173 offset:2176
buffer_load_dwordx4 v153, s[8:11], s52 offen offset:1024 lds
s_waitcnt lgkmcnt(7)
v_mfma_f32_32x32x16_bf16 v[88:103], v[144:147], v[120:123], v[88:103]
buffer_load_dwordx4 v154, s[8:11], s52 offen offset:2048 lds
buffer_load_dwordx4 v155, s[8:11], s52 offen offset:3072 lds
s_waitcnt lgkmcnt(4)
v_mfma_f32_32x32x16_bf16 v[24:39], v[148:151], v[124:127], v[24:39]
ds_read_b64_tr_b16 v[144:145], v170 offset:57344
ds_read_b64_tr_b16 v[146:147], v170 offset:58368
s_waitcnt lgkmcnt(5)
v_mfma_f32_32x32x16_bf16 v[40:55], v[148:151], v[128:131], v[40:55]
ds_read_b128 v[104:107], v164 offset:32768
ds_read_b128 v[108:111], v164 offset:36864
s_waitcnt lgkmcnt(6)
v_mfma_f32_32x32x16_bf16 v[56:71], v[148:151], v[132:135], v[56:71]
ds_read_b128 v[112:115], v164 offset:40960
ds_read_b128 v[116:119], v164 offset:45056
s_waitcnt lgkmcnt(7)
v_mfma_f32_32x32x16_bf16 v[72:87], v[148:151], v[136:139], v[72:87]
ds_read_b128 v[120:123], v174 offset:2176
s_add_u32 s45, s45, 1
s_cmp_eq_u32 s45, 10
s_cselect_b32 s45, 0, s45
s_add_u32 m0, s46, 16384
s_mul_i32 s54, s45, 245760
s_add_u32 s54, s54, s43
buffer_load_dwordx4 v156, s[12:15], s54 offen lds
s_waitcnt lgkmcnt(7)
v_mfma_f32_32x32x16_bf16 v[88:103], v[148:151], v[140:143], v[88:103]
buffer_load_dwordx4 v157, s[12:15], s54 offen offset:1024 lds
buffer_load_dwordx4 v158, s[12:15], s54 offen offset:2048 lds
s_waitcnt lgkmcnt(4)
v_mfma_f32_32x32x16_bf16 v[24:39], v[144:147], v[104:107], v[24:39]
ds_read_b64_tr_b16 v[148:149], v170 offset:61440
ds_read_b64_tr_b16 v[150:151], v170 offset:62464
s_waitcnt lgkmcnt(5)
v_mfma_f32_32x32x16_bf16 v[40:55], v[144:147], v[108:111], v[40:55]
ds_read_b128 v[124:127], v165 offset:32768
ds_read_b128 v[128:131], v165 offset:36864
s_waitcnt lgkmcnt(6)
v_mfma_f32_32x32x16_bf16 v[56:71], v[144:147], v[112:115], v[56:71]
ds_read_b128 v[132:135], v165 offset:40960
ds_read_b128 v[136:139], v165 offset:45056
s_waitcnt lgkmcnt(7)
v_mfma_f32_32x32x16_bf16 v[72:87], v[144:147], v[116:119], v[72:87]
ds_read_b128 v[140:143], v175 offset:2176
buffer_load_dwordx4 v159, s[12:15], s54 offen offset:3072 lds
s_waitcnt lgkmcnt(7)
v_mfma_f32_32x32x16_bf16 v[88:103], v[144:147], v[120:123], v[88:103]
s_lshl_b32 s51, s45, 7
s_cmp_lg_u32 s50, 0
s_cbranch_scc1 Lh_7
s_add_u32 m0, s49, 139776
s_add_u32 s53, s51, s44
buffer_load_dwordx4 v160, s[8:11], s53 offen lds
Lh_7:
s_add_u32 m0, s46, 0
s_add_u32 s52, s51, s42
buffer_load_dwordx4 v152, s[8:11], s52 offen lds
s_waitcnt lgkmcnt(4)
v_mfma_f32_32x32x16_bf16 v[24:39], v[148:151], v[124:127], v[24:39]
s_waitcnt vmcnt(13)
s_waitcnt lgkmcnt(0)
s_barrier
ds_read_b64_tr_b16 v[144:145], v171 offset:16384
ds_read_b64_tr_b16 v[146:147], v171 offset:17408
v_mfma_f32_32x32x16_bf16 v[40:55], v[148:151], v[128:131], v[40:55]
ds_read_b128 v[104:107], v166 offset:0
ds_read_b128 v[108:111], v166 offset:4096
v_mfma_f32_32x32x16_bf16 v[56:71], v[148:151], v[132:135], v[56:71]
ds_read_b128 v[112:115], v166 offset:8192
ds_read_b128 v[116:119], v166 offset:12288
v_mfma_f32_32x32x16_bf16 v[72:87], v[148:151], v[136:139], v[72:87]
ds_read_b128 v[120:123], v172 offset:4352
buffer_load_dwordx4 v153, s[8:11], s52 offen offset:1024 lds
v_mfma_f32_32x32x16_bf16 v[88:103], v[148:151], v[140:143], v[88:103]
buffer_load_dwordx4 v154, s[8:11], s52 offen offset:2048 lds
buffer_load_dwordx4 v155, s[8:11], s52 offen offset:3072 lds
s_waitcnt lgkmcnt(4)
v_mfma_f32_32x32x16_bf16 v[24:39], v[144:147], v[104:107], v[24:39]
ds_read_b64_tr_b16 v[148:149], v171 offset:20480
ds_read_b64_tr_b16 v[150:151], v171 offset:21504
s_waitcnt lgkmcnt(5)
v_mfma_f32_32x32x16_bf16 v[40:55], v[144:147], v[108:111], v[40:55]
ds_read_b128 v[124:127], v167 offset:0
ds_read_b128 v[128:131], v167 offset:4096
s_waitcnt lgkmcnt(6)
v_mfma_f32_32x32x16_bf16 v[56:71], v[144:147], v[112:115], v[56:71]
ds_read_b128 v[132:135], v167 offset:8192
ds_read_b128 v[136:139], v167 offset:12288
s_waitcnt lgkmcnt(7)
v_mfma_f32_32x32x16_bf16 v[72:87], v[144:147], v[116:119], v[72:87]
ds_read_b128 v[140:143], v173 offset:4352
s_add_u32 s45, s45, 1
s_cmp_eq_u32 s45, 10
s_cselect_b32 s45, 0, s45
s_add_u32 m0, s46, 49152
s_mul_i32 s54, s45, 245760
s_add_u32 s54, s54, s43
buffer_load_dwordx4 v156, s[12:15], s54 offen lds
s_waitcnt lgkmcnt(7)
v_mfma_f32_32x32x16_bf16 v[88:103], v[144:147], v[120:123], v[88:103]
buffer_load_dwordx4 v157, s[12:15], s54 offen offset:1024 lds
buffer_load_dwordx4 v158, s[12:15], s54 offen offset:2048 lds
s_waitcnt lgkmcnt(4)
v_mfma_f32_32x32x16_bf16 v[24:39], v[148:151], v[124:127], v[24:39]
ds_read_b64_tr_b16 v[144:145], v171 offset:24576
ds_read_b64_tr_b16 v[146:147], v171 offset:25600
s_waitcnt lgkmcnt(5)
v_mfma_f32_32x32x16_bf16 v[40:55], v[148:151], v[128:131], v[40:55]
ds_read_b128 v[104:107], v168 offset:0
ds_read_b128 v[108:111], v168 offset:4096
s_waitcnt lgkmcnt(6)
v_mfma_f32_32x32x16_bf16 v[56:71], v[148:151], v[132:135], v[56:71]
ds_read_b128 v[112:115], v168 offset:8192
ds_read_b128 v[116:119], v168 offset:12288
s_waitcnt lgkmcnt(7)
v_mfma_f32_32x32x16_bf16 v[72:87], v[148:151], v[136:139], v[72:87]
ds_read_b128 v[120:123], v174 offset:4352
buffer_load_dwordx4 v159, s[12:15], s54 offen offset:3072 lds
s_waitcnt lgkmcnt(7)
v_mfma_f32_32x32x16_bf16 v[88:103], v[148:151], v[140:143], v[88:103]
s_lshl_b32 s51, s45, 7
s_cmp_lg_u32 s50, 0
s_cbranch_scc1 Lh_8
s_add_u32 m0, s49, 141952
s_add_u32 s53, s51, s44
buffer_load_dwordx4 v160, s[8:11], s53 offen lds
Lh_8:
s_add_u32 m0, s46, 32768
s_add_u32 s52, s51, s42
buffer_load_dwordx4 v152, s[8:11], s52 offen lds
s_waitcnt lgkmcnt(4)
v_mfma_f32_32x32x16_bf16 v[24:39], v[144:147], v[104:107], v[24:39]
ds_read_b64_tr_b16 v[148:149], v171 offset:28672
ds_read_b64_tr_b16 v[150:151], v171 offset:29696
s_waitcnt lgkmcnt(5)
v_mfma_f32_32x32x16_bf16 v[40:55], v[144:147], v[108:111], v[40:55]
ds_read_b128 v[124:127], v169 offset:0
ds_read_b128 v[128:131], v169 offset:4096
s_waitcnt lgkmcnt(6)
v_mfma_f32_32x32x16_bf16 v[56:71], v[144:147], v[112:115], v[56:71]
ds_read_b128 v[132:135], v169 offset:8192
ds_read_b128 v[136:139], v169 offset:12288
s_waitcnt lgkmcnt(7)
v_mfma_f32_32x32x16_bf16 v[72:87], v[144:147], v[116:119], v[72:87]
ds_read_b128 v[140:143], v175 offset:4352
buffer_load_dwordx4 v153, s[8:11], s52 offen offset:1024 lds
s_waitcnt lgkmcnt(7)
v_mfma_f32_32x32x16_bf16 v[88:103], v[144:147], v[120:123], v[88:103]
buffer_load_dwordx4 v154, s[8:11], s52 offen offset:2048 lds
buffer_load_dwordx4 v155, s[8:11], s52 offen offset:3072 lds
s_waitcnt lgkmcnt(4)
v_mfma_f32_32x32x16_bf16 v[24:39], v[148:151], v[124:127], v[24:39]
s_waitcnt vmcnt(16)
s_waitcnt lgkmcnt(0)
s_barrier
ds_read_b64_tr_b16 v[144:145], v171 offset:49152
ds_read_b64_tr_b16 v[146:147], v171 offset:50176
v_mfma_f32_32x32x16_bf16 v[40:55], v[148:151], v[128:131], v[40:55]
ds_read_b128 v[104:107], v166 offset:32768
ds_read_b128 v[108:111], v166 offset:36864
v_mfma_f32_32x32x16_bf16 v[56:71], v[148:151], v[132:135], v[56:71]
ds_read_b128 v[112:115], v166 offset:40960
ds_read_b128 v[116:119], v166 offset:45056
v_mfma_f32_32x32x16_bf16 v[72:87], v[148:151], v[136:139], v[72:87]
ds_read_b128 v[120:123], v172 offset:6528
s_add_u32 s45, s45, 1
s_cmp_eq_u32 s45, 10
s_cselect_b32 s45, 0, s45
s_add_u32 m0, s46, 81920
s_mul_i32 s54, s45, 245760
s_add_u32 s54, s54, s43
buffer_load_dwordx4 v156, s[12:15], s54 offen lds
v_mfma_f32_32x32x16_bf16 v[88:103], v[148:151], v[140:143], v[88:103]
buffer_load_dwordx4 v157, s[12:15], s54 offen offset:1024 lds
buffer_load_dwordx4 v158, s[12:15], s54 offen offset:2048 lds
s_waitcnt lgkmcnt(4)
v_mfma_f32_32x32x16_bf16 v[24:39], v[144:147], v[104:107], v[24:39]
ds_read_b64_tr_b16 v[148:149], v171 offset:53248
ds_read_b64_tr_b16 v[150:151], v171 offset:54272
s_waitcnt lgkmcnt(5)
v_mfma_f32_32x32x16_bf16 v[40:55], v[144:147], v[108:111], v[40:55]
ds_read_b128 v[124:127], v167 offset:32768
ds_read_b128 v[128:131], v167 offset:36864
s_waitcnt lgkmcnt(6)
v_mfma_f32_32x32x16_bf16 v[56:71], v[144:147], v[112:115], v[56:71]
ds_read_b128 v[132:135], v167 offset:40960
ds_read_b128 v[136:139], v167 offset:45056
s_waitcnt lgkmcnt(7)
v_mfma_f32_32x32x16_bf16 v[72:87], v[144:147], v[116:119], v[72:87]
ds_read_b128 v[140:143], v173 offset:6528
buffer_load_dwordx4 v159, s[12:15], s54 offen offset:3072 lds
s_waitcnt lgkmcnt(7)
v_mfma_f32_32x32x16_bf16 v[88:103], v[144:147], v[120:123], v[88:103]
s_lshl_b32 s51, s45, 7
s_cmp_lg_u32 s50, 0
s_cbranch_scc1 Lh_9
s_add_u32 m0, s49, 144128
s_add_u32 s53, s51, s44
buffer_load_dwordx4 v160, s[8:11], s53 offen lds
Lh_9:
s_add_u32 m0, s46, 65536
s_add_u32 s52, s51, s42
buffer_load_dwordx4 v152, s[8:11], s52 offen lds
s_waitcnt lgkmcnt(4)
v_mfma_f32_32x32x16_bf16 v[24:39], v[148:151], v[124:127], v[24:39]
ds_read_b64_tr_b16 v[144:145], v171 offset:57344
ds_read_b64_tr_b16 v[146:147], v171 offset:58368
s_waitcnt lgkmcnt(5)
v_mfma_f32_32x32x16_bf16 v[40:55], v[148:151], v[128:131], v[40:55]
ds_read_b128 v[104:107], v168 offset:32768
ds_read_b128 v[108:111], v168 offset:36864
s_waitcnt lgkmcnt(6)
v_mfma_f32_32x32x16_bf16 v[56:71], v[148:151], v[132:135], v[56:71]
ds_read_b128 v[112:115], v168 offset:40960
ds_read_b128 v[116:119], v168 offset:45056
s_waitcnt lgkmcnt(7)
v_mfma_f32_32x32x16_bf16 v[72:87], v[148:151], v[136:139], v[72:87]
ds_read_b128 v[120:123], v174 offset:6528
buffer_load_dwordx4 v153, s[8:11], s52 offen offset:1024 lds
s_waitcnt lgkmcnt(7)
v_mfma_f32_32x32x16_bf16 v[88:103], v[148:151], v[140:143], v[88:103]
buffer_load_dwordx4 v154, s[8:11], s52 offen offset:2048 lds
buffer_load_dwordx4 v155, s[8:11], s52 offen offset:3072 lds
s_waitcnt lgkmcnt(4)
v_mfma_f32_32x32x16_bf16 v[24:39], v[144:147], v[104:107], v[24:39]
ds_read_b64_tr_b16 v[148:149], v171 offset:61440
ds_read_b64_tr_b16 v[150:151], v171 offset:62464
s_waitcnt lgkmcnt(5)
v_mfma_f32_32x32x16_bf16 v[40:55], v[144:147], v[108:111], v[40:55]
ds_read_b128 v[124:127], v169 offset:32768
s_waitcnt lgkmcnt(5)
v_mfma_f32_32x32x16_bf16 v[56:71], v[144:147], v[112:115], v[56:71]
ds_read_b128 v[128:131], v169 offset:36864
ds_read_b128 v[132:135], v169 offset:40960
s_waitcnt lgkmcnt(6)
v_mfma_f32_32x32x16_bf16 v[72:87], v[144:147], v[116:119], v[72:87]
ds_read_b128 v[136:139], v169 offset:45056
s_waitcnt lgkmcnt(6)
v_mfma_f32_32x32x16_bf16 v[88:103], v[144:147], v[120:123], v[88:103]
ds_read_b128 v[140:143], v175 offset:6528
s_waitcnt lgkmcnt(4)
v_mfma_f32_32x32x16_bf16 v[24:39], v[148:151], v[124:127], v[24:39]
s_waitcnt vmcnt(16)
s_waitcnt lgkmcnt(0)
s_barrier
ds_read_b64_tr_b16 v[144:145], v170 offset:16384
ds_read_b64_tr_b16 v[146:147], v170 offset:17408
v_mfma_f32_32x32x16_bf16 v[40:55], v[148:151], v[128:131], v[40:55]
ds_read_b128 v[104:107], v162 offset:0
ds_read_b128 v[108:111], v162 offset:4096
v_mfma_f32_32x32x16_bf16 v[56:71], v[148:151], v[132:135], v[56:71]
ds_read_b128 v[112:115], v162 offset:8192
ds_read_b128 v[116:119], v162 offset:12288
v_mfma_f32_32x32x16_bf16 v[72:87], v[148:151], v[136:139], v[72:87]
ds_read_b128 v[120:123], v172 offset:8704
s_add_u32 s45, s45, 1
s_cmp_eq_u32 s45, 10
s_cselect_b32 s45, 0, s45
s_add_u32 m0, s46, 114688
s_mul_i32 s54, s45, 245760
s_add_u32 s54, s54, s43
buffer_load_dwordx4 v156, s[12:15], s54 offen lds
v_mfma_f32_32x32x16_bf16 v[88:103], v[148:151], v[140:143], v[88:103]
buffer_load_dwordx4 v157, s[12:15], s54 offen offset:1024 lds
buffer_load_dwordx4 v158, s[12:15], s54 offen offset:2048 lds
s_waitcnt lgkmcnt(4)
v_mfma_f32_32x32x16_bf16 v[24:39], v[144:147], v[104:107], v[24:39]
ds_read_b64_tr_b16 v[148:149], v170 offset:20480
ds_read_b64_tr_b16 v[150:151], v170 offset:21504
s_waitcnt lgkmcnt(5)
v_mfma_f32_32x32x16_bf16 v[40:55], v[144:147], v[108:111], v[40:55]
ds_read_b128 v[124:127], v163 offset:0
ds_read_b128 v[128:131], v163 offset:4096
s_waitcnt lgkmcnt(6)
v_mfma_f32_32x32x16_bf16 v[56:71], v[144:147], v[112:115], v[56:71]
ds_read_b128 v[132:135], v163 offset:8192
ds_read_b128 v[136:139], v163 offset:12288
s_waitcnt lgkmcnt(7)
v_mfma_f32_32x32x16_bf16 v[72:87], v[144:147], v[116:119], v[72:87]
ds_read_b128 v[140:143], v173 offset:8704
buffer_load_dwordx4 v159, s[12:15], s54 offen offset:3072 lds
s_waitcnt lgkmcnt(7)
v_mfma_f32_32x32x16_bf16 v[88:103], v[144:147], v[120:123], v[88:103]
s_lshl_b32 s51, s45, 7
s_cmp_lg_u32 s50, 0
s_cbranch_scc1 Lh_10
s_add_u32 m0, s49, 146304
s_add_u32 s53, s51, s44
buffer_load_dwordx4 v160, s[8:11], s53 offen lds
Lh_10:
s_add_u32 m0, s46, 98304
s_add_u32 s52, s51, s42
buffer_load_dwordx4 v152, s[8:11], s52 offen lds
s_waitcnt lgkmcnt(4)
v_mfma_f32_32x32x16_bf16 v[24:39], v[148:151], v[124:127], v[24:39]
ds_read_b64_tr_b16 v[144:145], v170 offset:24576
ds_read_b64_tr_b16 v[146:147], v170 offset:25600
s_waitcnt lgkmcnt(5)
v_mfma_f32_32x32x16_bf16 v[40:55], v[148:151], v[128:131], v[40:55]
ds_read_b128 v[104:107], v164 offset:0
ds_read_b128 v[108:111], v164 offset:4096
s_waitcnt lgkmcnt(6)
v_mfma_f32_32x32x16_bf16 v[56:71], v[148:151], v[132:135], v[56:71]
ds_read_b128 v[112:115], v164 offset:8192
ds_read_b128 v[116:119], v164 offset:12288
s_waitcnt lgkmcnt(7)
v_mfma_f32_32x32x16_bf16 v[72:87], v[148:151], v[136:139], v[72:87]
ds_read_b128 v[120:123], v174 offset:8704
buffer_load_dwordx4 v153, s[8:11], s52 offen offset:1024 lds
s_waitcnt lgkmcnt(7)
v_mfma_f32_32x32x16_bf16 v[88:103], v[148:151], v[140:143], v[88:103]
buffer_load_dwordx4 v154, s[8:11], s52 offen offset:2048 lds
buffer_load_dwordx4 v155, s[8:11], s52 offen offset:3072 lds
s_waitcnt lgkmcnt(4)
v_mfma_f32_32x32x16_bf16 v[24:39], v[144:147], v[104:107], v[24:39]
ds_read_b64_tr_b16 v[148:149], v170 offset:28672
ds_read_b64_tr_b16 v[150:151], v170 offset:29696
s_waitcnt lgkmcnt(5)
v_mfma_f32_32x32x16_bf16 v[40:55], v[144:147], v[108:111], v[40:55]
ds_read_b128 v[124:127], v165 offset:0
s_waitcnt lgkmcnt(5)
v_mfma_f32_32x32x16_bf16 v[56:71], v[144:147], v[112:115], v[56:71]
ds_read_b128 v[128:131], v165 offset:4096
ds_read_b128 v[132:135], v165 offset:8192
s_waitcnt lgkmcnt(6)
v_mfma_f32_32x32x16_bf16 v[72:87], v[144:147], v[116:119], v[72:87]
ds_read_b128 v[136:139], v165 offset:12288
s_waitcnt lgkmcnt(6)
v_mfma_f32_32x32x16_bf16 v[88:103], v[144:147], v[120:123], v[88:103]
ds_read_b128 v[140:143], v175 offset:8704
s_waitcnt lgkmcnt(4)
v_mfma_f32_32x32x16_bf16 v[24:39], v[148:151], v[124:127], v[24:39]
s_waitcnt vmcnt(16)
s_waitcnt lgkmcnt(0)
s_barrier
ds_read_b64_tr_b16 v[144:145], v170 offset:49152
ds_read_b64_tr_b16 v[146:147], v170 offset:50176
v_mfma_f32_32x32x16_bf16 v[40:55], v[148:151], v[128:131], v[40:55]
ds_read_b128 v[104:107], v162 offset:32768
ds_read_b128 v[108:111], v162 offset:36864
v_mfma_f32_32x32x16_bf16 v[56:71], v[148:151], v[132:135], v[56:71]
ds_read_b128 v[112:115], v162 offset:40960
ds_read_b128 v[116:119], v162 offset:45056
v_mfma_f32_32x32x16_bf16 v[72:87], v[148:151], v[136:139], v[72:87]
ds_read_b128 v[120:123], v172 offset:10880
s_add_u32 s45, s45, 1
s_cmp_eq_u32 s45, 10
s_cselect_b32 s45, 0, s45
s_add_u32 m0, s46, 16384
s_mul_i32 s54, s45, 245760
s_add_u32 s54, s54, s43
buffer_load_dwordx4 v156, s[12:15], s54 offen lds
v_mfma_f32_32x32x16_bf16 v[88:103], v[148:151], v[140:143], v[88:103]
buffer_load_dwordx4 v157, s[12:15], s54 offen offset:1024 lds
buffer_load_dwordx4 v158, s[12:15], s54 offen offset:2048 lds
s_waitcnt lgkmcnt(4)
v_mfma_f32_32x32x16_bf16 v[24:39], v[144:147], v[104:107], v[24:39]
ds_read_b64_tr_b16 v[148:149], v170 offset:53248
ds_read_b64_tr_b16 v[150:151], v170 offset:54272
s_waitcnt lgkmcnt(5)
v_mfma_f32_32x32x16_bf16 v[40:55], v[144:147], v[108:111], v[40:55]
ds_read_b128 v[124:127], v163 offset:32768
ds_read_b128 v[128:131], v163 offset:36864
s_waitcnt lgkmcnt(6)
v_mfma_f32_32x32x16_bf16 v[56:71], v[144:147], v[112:115], v[56:71]
ds_read_b128 v[132:135], v163 offset:40960
ds_read_b128 v[136:139], v163 offset:45056
s_waitcnt lgkmcnt(7)
v_mfma_f32_32x32x16_bf16 v[72:87], v[144:147], v[116:119], v[72:87]
ds_read_b128 v[140:143], v173 offset:10880
buffer_load_dwordx4 v159, s[12:15], s54 offen offset:3072 lds
s_waitcnt lgkmcnt(7)
v_mfma_f32_32x32x16_bf16 v[88:103], v[144:147], v[120:123], v[88:103]
s_lshl_b32 s51, s45, 7
s_cmp_lg_u32 s50, 0
s_cbranch_scc1 Lh_11
s_add_u32 m0, s49, 148480
s_add_u32 s53, s51, s44
buffer_load_dwordx4 v160, s[8:11], s53 offen lds
Lh_11:
s_add_u32 m0, s46, 0
s_add_u32 s52, s51, s42
buffer_load_dwordx4 v152, s[8:11], s52 offen lds
s_waitcnt lgkmcnt(4)
v_mfma_f32_32x32x16_bf16 v[24:39], v[148:151], v[124:127], v[24:39]
ds_read_b64_tr_b16 v[144:145], v170 offset:57344
ds_read_b64_tr_b16 v[146:147], v170 offset:58368
s_waitcnt lgkmcnt(5)
v_mfma_f32_32x32x16_bf16 v[40:55], v[148:151], v[128:131], v[40:55]
ds_read_b128 v[104:107], v164 offset:32768
ds_read_b128 v[108:111], v164 offset:36864
s_waitcnt lgkmcnt(6)
v_mfma_f32_32x32x16_bf16 v[56:71], v[148:151], v[132:135], v[56:71]
ds_read_b128 v[112:115], v164 offset:40960
ds_read_b128 v[116:119], v164 offset:45056
s_waitcnt lgkmcnt(7)
v_mfma_f32_32x32x16_bf16 v[72:87], v[148:151], v[136:139], v[72:87]
ds_read_b128 v[120:123], v174 offset:10880
buffer_load_dwordx4 v153, s[8:11], s52 offen offset:1024 lds
s_waitcnt lgkmcnt(7)
v_mfma_f32_32x32x16_bf16 v[88:103], v[148:151], v[140:143], v[88:103]
buffer_load_dwordx4 v154, s[8:11], s52 offen offset:2048 lds
buffer_load_dwordx4 v155, s[8:11], s52 offen offset:3072 lds
s_waitcnt lgkmcnt(4)
v_mfma_f32_32x32x16_bf16 v[24:39], v[144:147], v[104:107], v[24:39]
ds_read_b64_tr_b16 v[148:149], v170 offset:61440
ds_read_b64_tr_b16 v[150:151], v170 offset:62464
s_waitcnt lgkmcnt(5)
v_mfma_f32_32x32x16_bf16 v[40:55], v[144:147], v[108:111], v[40:55]
ds_read_b128 v[124:127], v165 offset:32768
s_waitcnt lgkmcnt(5)
v_mfma_f32_32x32x16_bf16 v[56:71], v[144:147], v[112:115], v[56:71]
ds_read_b128 v[128:131], v165 offset:36864
ds_read_b128 v[132:135], v165 offset:40960
s_waitcnt lgkmcnt(6)
v_mfma_f32_32x32x16_bf16 v[72:87], v[144:147], v[116:119], v[72:87]
ds_read_b128 v[136:139], v165 offset:45056
s_waitcnt lgkmcnt(6)
v_mfma_f32_32x32x16_bf16 v[88:103], v[144:147], v[120:123], v[88:103]
ds_read_b128 v[140:143], v175 offset:10880
s_waitcnt lgkmcnt(4)
v_mfma_f32_32x32x16_bf16 v[24:39], v[148:151], v[124:127], v[24:39]
s_waitcnt vmcnt(16)
s_waitcnt lgkmcnt(0)
s_barrier
ds_read_b64_tr_b16 v[144:145], v171 offset:16384
ds_read_b64_tr_b16 v[146:147], v171 offset:17408
v_mfma_f32_32x32x16_bf16 v[40:55], v[148:151], v[128:131], v[40:55]
ds_read_b128 v[104:107], v166 offset:0
ds_read_b128 v[108:111], v166 offset:4096
v_mfma_f32_32x32x16_bf16 v[56:71], v[148:151], v[132:135], v[56:71]
ds_read_b128 v[112:115], v166 offset:8192
ds_read_b128 v[116:119], v166 offset:12288
v_mfma_f32_32x32x16_bf16 v[72:87], v[148:151], v[136:139], v[72:87]
ds_read_b128 v[120:123], v172 offset:13056
s_add_u32 s45, s45, 1
s_cmp_eq_u32 s45, 10
s_cselect_b32 s45, 0, s45
s_add_u32 m0, s46, 49152
s_mul_i32 s54, s45, 245760
s_add_u32 s54, s54, s43
buffer_load_dwordx4 v156, s[12:15], s54 offen lds
v_mfma_f32_32x32x16_bf16 v[88:103], v[148:151], v[140:143], v[88:103]
buffer_load_dwordx4 v157, s[12:15], s54 offen offset:1024 lds
buffer_load_dwordx4 v158, s[12:15], s54 offen offset:2048 lds
s_waitcnt lgkmcnt(4)
v_mfma_f32_32x32x16_bf16 v[24:39], v[144:147], v[104:107], v[24:39]
ds_read_b64_tr_b16 v[148:149], v171 offset:20480
ds_read_b64_tr_b16 v[150:151], v171 offset:21504
s_waitcnt lgkmcnt(5)
v_mfma_f32_32x32x16_bf16 v[40:55], v[144:147], v[108:111], v[40:55]
ds_read_b128 v[124:127], v167 offset:0
ds_read_b128 v[128:131], v167 offset:4096
s_waitcnt lgkmcnt(6)
v_mfma_f32_32x32x16_bf16 v[56:71], v[144:147], v[112:115], v[56:71]
ds_read_b128 v[132:135], v167 offset:8192
ds_read_b128 v[136:139], v167 offset:12288
s_waitcnt lgkmcnt(7)
v_mfma_f32_32x32x16_bf16 v[72:87], v[144:147], v[116:119], v[72:87]
ds_read_b128 v[140:143], v173 offset:13056
buffer_load_dwordx4 v159, s[12:15], s54 offen offset:3072 lds
s_waitcnt lgkmcnt(7)
v_mfma_f32_32x32x16_bf16 v[88:103], v[144:147], v[120:123], v[88:103]
s_lshl_b32 s51, s45, 7
s_cmp_lg_u32 s50, 0
s_cbranch_scc1 Lh_12
s_add_u32 m0, s49, 150656
s_add_u32 s53, s51, s44
buffer_load_dwordx4 v160, s[8:11], s53 offen lds
Lh_12:
s_add_u32 m0, s46, 32768
s_add_u32 s52, s51, s42
buffer_load_dwordx4 v152, s[8:11], s52 offen lds
s_waitcnt lgkmcnt(4)
v_mfma_f32_32x32x16_bf16 v[24:39], v[148:151], v[124:127], v[24:39]
ds_read_b64_tr_b16 v[144:145], v171 offset:24576
ds_read_b64_tr_b16 v[146:147], v171 offset:25600
s_waitcnt lgkmcnt(5)
v_mfma_f32_32x32x16_bf16 v[40:55], v[148:151], v[128:131], v[40:55]
ds_read_b128 v[104:107], v168 offset:0
ds_read_b128 v[108:111], v168 offset:4096
s_waitcnt lgkmcnt(6)
v_mfma_f32_32x32x16_bf16 v[56:71], v[148:151], v[132:135], v[56:71]
ds_read_b128 v[112:115], v168 offset:8192
ds_read_b128 v[116:119], v168 offset:12288
s_waitcnt lgkmcnt(7)
v_mfma_f32_32x32x16_bf16 v[72:87], v[148:151], v[136:139], v[72:87]
ds_read_b128 v[120:123], v174 offset:13056
buffer_load_dwordx4 v153, s[8:11], s52 offen offset:1024 lds
s_waitcnt lgkmcnt(7)
v_mfma_f32_32x32x16_bf16 v[88:103], v[148:151], v[140:143], v[88:103]
buffer_load_dwordx4 v154, s[8:11], s52 offen offset:2048 lds
buffer_load_dwordx4 v155, s[8:11], s52 offen offset:3072 lds
s_waitcnt lgkmcnt(4)
v_mfma_f32_32x32x16_bf16 v[24:39], v[144:147], v[104:107], v[24:39]
ds_read_b64_tr_b16 v[148:149], v171 offset:28672
ds_read_b64_tr_b16 v[150:151], v171 offset:29696
s_waitcnt lgkmcnt(5)
v_mfma_f32_32x32x16_bf16 v[40:55], v[144:147], v[108:111], v[40:55]
ds_read_b128 v[124:127], v169 offset:0
s_waitcnt lgkmcnt(5)
v_mfma_f32_32x32x16_bf16 v[56:71], v[144:147], v[112:115], v[56:71]
ds_read_b128 v[128:131], v169 offset:4096
ds_read_b128 v[132:135], v169 offset:8192
s_waitcnt lgkmcnt(6)
v_mfma_f32_32x32x16_bf16 v[72:87], v[144:147], v[116:119], v[72:87]
ds_read_b128 v[136:139], v169 offset:12288
s_waitcnt lgkmcnt(6)
v_mfma_f32_32x32x16_bf16 v[88:103], v[144:147], v[120:123], v[88:103]
ds_read_b128 v[140:143], v175 offset:13056
s_waitcnt lgkmcnt(4)
v_mfma_f32_32x32x16_bf16 v[24:39], v[148:151], v[124:127], v[24:39]
s_waitcnt vmcnt(16)
s_waitcnt lgkmcnt(0)
s_barrier
ds_read_b64_tr_b16 v[144:145], v171 offset:49152
ds_read_b64_tr_b16 v[146:147], v171 offset:50176
v_mfma_f32_32x32x16_bf16 v[40:55], v[148:151], v[128:131], v[40:55]
ds_read_b128 v[104:107], v166 offset:32768
ds_read_b128 v[108:111], v166 offset:36864
v_mfma_f32_32x32x16_bf16 v[56:71], v[148:151], v[132:135], v[56:71]
ds_read_b128 v[112:115], v166 offset:40960
ds_read_b128 v[116:119], v166 offset:45056
ds_read_b128 v[120:123], v172 offset:15232
v_mfma_f32_32x32x16_bf16 v[72:87], v[148:151], v[136:139], v[72:87]
buffer_load_dwordx4 v[184:187], v222, s[32:35], s55 offen offset:0 sc1
buffer_load_dwordx4 v[188:191], v222, s[32:35], s55 offen offset:512 sc1
v_mfma_f32_32x32x16_bf16 v[88:103], v[148:151], v[140:143], v[88:103]
buffer_load_dwordx4 v[192:195], v222, s[32:35], s55 offen offset:1024 sc1
buffer_load_dwordx4 v[196:199], v222, s[32:35], s55 offen offset:1536 sc1
s_waitcnt lgkmcnt(4)
v_mfma_f32_32x32x16_bf16 v[24:39], v[144:147], v[104:107], v[24:39]
ds_read_b64_tr_b16 v[148:149], v171 offset:53248
ds_read_b64_tr_b16 v[150:151], v171 offset:54272
s_waitcnt lgkmcnt(5)
v_mfma_f32_32x32x16_bf16 v[40:55], v[144:147], v[108:111], v[40:55]
ds_read_b128 v[124:127], v167 offset:32768
ds_read_b128 v[128:131], v167 offset:36864
s_waitcnt lgkmcnt(6)
v_mfma_f32_32x32x16_bf16 v[56:71], v[144:147], v[112:115], v[56:71]
ds_read_b128 v[132:135], v167 offset:40960
ds_read_b128 v[136:139], v167 offset:45056
s_waitcnt lgkmcnt(7)
v_mfma_f32_32x32x16_bf16 v[72:87], v[144:147], v[116:119], v[72:87]
ds_read_b128 v[140:143], v173 offset:15232
s_mov_b32 s3, 1703936
buffer_load_dwordx4 v[200:203], v223, s[32:35], s3 offen sc1
s_waitcnt lgkmcnt(7)
v_mfma_f32_32x32x16_bf16 v[88:103], v[144:147], v[120:123], v[88:103]
s_add_u32 m0, s47, 65536
s_add_u32 s101, s93, 0
buffer_load_dwordx4 v240, s[20:23], s101 offen offset:0  lds
buffer_load_dwordx4 v241, s[20:23], s101 offen offset:1024  lds
s_waitcnt lgkmcnt(4)
v_mfma_f32_32x32x16_bf16 v[24:39], v[148:151], v[124:127], v[24:39]
ds_read_b64_tr_b16 v[144:145], v171 offset:57344
ds_read_b64_tr_b16 v[146:147], v171 offset:58368
s_waitcnt lgkmcnt(5)
v_mfma_f32_32x32x16_bf16 v[40:55], v[148:151], v[128:131], v[40:55]
ds_read_b128 v[104:107], v168 offset:32768
ds_read_b128 v[108:111], v168 offset:36864
s_waitcnt lgkmcnt(6)
v_mfma_f32_32x32x16_bf16 v[56:71], v[148:151], v[132:135], v[56:71]
ds_read_b128 v[112:115], v168 offset:40960
ds_read_b128 v[116:119], v168 offset:45056
s_waitcnt lgkmcnt(7)
v_mfma_f32_32x32x16_bf16 v[72:87], v[148:151], v[136:139], v[72:87]
ds_read_b128 v[120:123], v174 offset:15232
buffer_load_dwordx4 v242, s[20:23], s101 offen offset:2048  lds
s_waitcnt lgkmcnt(7)
v_mfma_f32_32x32x16_bf16 v[88:103], v[148:151], v[140:143], v[88:103]
buffer_load_dwordx4 v243, s[20:23], s101 offen offset:3072  lds
s_add_u32 m0, s47, 69632
s_add_u32 s101, s93, 221184
buffer_load_dwordx4 v240, s[20:23], s101 offen offset:0  lds
s_waitcnt lgkmcnt(4)
v_mfma_f32_32x32x16_bf16 v[24:39], v[144:147], v[104:107], v[24:39]
ds_read_b64_tr_b16 v[148:149], v171 offset:61440
ds_read_b64_tr_b16 v[150:151], v171 offset:62464
s_waitcnt lgkmcnt(5)
v_mfma_f32_32x32x16_bf16 v[40:55], v[144:147], v[108:111], v[40:55]
ds_read_b128 v[124:127], v169 offset:32768
ds_read_b128 v[128:131], v169 offset:36864
s_waitcnt lgkmcnt(6)
v_mfma_f32_32x32x16_bf16 v[56:71], v[144:147], v[112:115], v[56:71]
ds_read_b128 v[132:135], v169 offset:40960
ds_read_b128 v[136:139], v169 offset:45056
s_waitcnt lgkmcnt(7)
v_mfma_f32_32x32x16_bf16 v[72:87], v[144:147], v[116:119], v[72:87]
ds_read_b128 v[140:143], v175 offset:15232
buffer_load_dwordx4 v241, s[20:23], s101 offen offset:1024  lds
s_waitcnt lgkmcnt(7)
v_mfma_f32_32x32x16_bf16 v[88:103], v[144:147], v[120:123], v[88:103]
buffer_load_dwordx4 v242, s[20:23], s101 offen offset:2048  lds
buffer_load_dwordx4 v243, s[20:23], s101 offen offset:3072  lds
s_waitcnt lgkmcnt(4)
v_mfma_f32_32x32x16_bf16 v[24:39], v[148:151], v[124:127], v[24:39]
s_waitcnt vmcnt(21)
s_waitcnt lgkmcnt(0)
s_barrier
ds_read_b64_tr_b16 v[144:145], v170 offset:16384
ds_read_b64_tr_b16 v[146:147], v170 offset:17408
v_mfma_f32_32x32x16_bf16 v[40:55], v[148:151], v[128:131], v[40:55]
ds_read_b128 v[104:107], v162 offset:0
ds_read_b128 v[108:111], v162 offset:4096
v_mfma_f32_32x32x16_bf16 v[56:71], v[148:151], v[132:135], v[56:71]
ds_read_b128 v[112:115], v162 offset:8192
ds_read_b128 v[116:119], v162 offset:12288
v_mfma_f32_32x32x16_bf16 v[72:87], v[148:151], v[136:139], v[72:87]
ds_read_b128 v[120:123], v172 offset:17408
s_add_u32 m0, s47, 98304
s_add_u32 s101, s93, 442368
buffer_load_dwordx4 v240, s[20:23], s101 offen offset:0  lds
v_mfma_f32_32x32x16_bf16 v[88:103], v[148:151], v[140:143], v[88:103]
buffer_load_dwordx4 v241, s[20:23], s101 offen offset:1024  lds
buffer_load_dwordx4 v242, s[20:23], s101 offen offset:2048  lds
s_waitcnt lgkmcnt(4)
v_mfma_f32_32x32x16_bf16 v[24:39], v[144:147], v[104:107], v[24:39]
ds_read_b64_tr_b16 v[148:149], v170 offset:20480
ds_read_b64_tr_b16 v[150:151], v170 offset:21504
s_waitcnt lgkmcnt(5)
v_mfma_f32_32x32x16_bf16 v[40:55], v[144:147], v[108:111], v[40:55]
ds_read_b128 v[124:127], v163 offset:0
ds_read_b128 v[128:131], v163 offset:4096
s_waitcnt lgkmcnt(6)
v_mfma_f32_32x32x16_bf16 v[56:71], v[144:147], v[112:115], v[56:71]
ds_read_b128 v[132:135], v163 offset:8192
ds_read_b128 v[136:139], v163 offset:12288
s_waitcnt lgkmcnt(7)
v_mfma_f32_32x32x16_bf16 v[72:87], v[144:147], v[116:119], v[72:87]
ds_read_b128 v[140:143], v173 offset:17408
buffer_load_dwordx4 v243, s[20:23], s101 offen offset:3072  lds
s_waitcnt lgkmcnt(7)
v_mfma_f32_32x32x16_bf16 v[88:103], v[144:147], v[120:123], v[88:103]
s_add_u32 m0, s47, 102400
s_add_u32 s101, s93, 663552
buffer_load_dwordx4 v240, s[20:23], s101 offen offset:0  lds
buffer_load_dwordx4 v241, s[20:23], s101 offen offset:1024  lds
s_waitcnt lgkmcnt(4)
v_mfma_f32_32x32x16_bf16 v[24:39], v[148:151], v[124:127], v[24:39]
ds_read_b64_tr_b16 v[144:145], v170 offset:24576
ds_read_b64_tr_b16 v[146:147], v170 offset:25600
s_waitcnt lgkmcnt(5)
v_mfma_f32_32x32x16_bf16 v[40:55], v[148:151], v[128:131], v[40:55]
ds_read_b128 v[104:107], v164 offset:0
ds_read_b128 v[108:111], v164 offset:4096
s_waitcnt lgkmcnt(6)
v_mfma_f32_32x32x16_bf16 v[56:71], v[148:151], v[132:135], v[56:71]
ds_read_b128 v[112:115], v164 offset:8192
ds_read_b128 v[116:119], v164 offset:12288
s_waitcnt lgkmcnt(7)
v_mfma_f32_32x32x16_bf16 v[72:87], v[148:151], v[136:139], v[72:87]
ds_read_b128 v[120:123], v174 offset:17408
buffer_load_dwordx4 v242, s[20:23], s101 offen offset:2048  lds
s_waitcnt lgkmcnt(7)
v_mfma_f32_32x32x16_bf16 v[88:103], v[148:151], v[140:143], v[88:103]
buffer_load_dwordx4 v243, s[20:23], s101 offen offset:3072  lds
s_waitcnt lgkmcnt(4)
v_mfma_f32_32x32x16_bf16 v[24:39], v[144:147], v[104:107], v[24:39]
ds_read_b64_tr_b16 v[148:149], v170 offset:28672
ds_read_b64_tr_b16 v[150:151], v170 offset:29696
s_waitcnt lgkmcnt(5)
v_mfma_f32_32x32x16_bf16 v[40:55], v[144:147], v[108:111], v[40:55]
ds_read_b128 v[124:127], v165 offset:0
s_waitcnt lgkmcnt(5)
v_mfma_f32_32x32x16_bf16 v[56:71], v[144:147], v[112:115], v[56:71]
ds_read_b128 v[128:131], v165 offset:4096
ds_read_b128 v[132:135], v165 offset:8192
s_waitcnt lgkmcnt(6)
v_mfma_f32_32x32x16_bf16 v[72:87], v[144:147], v[116:119], v[72:87]
ds_read_b128 v[136:139], v165 offset:12288
s_waitcnt lgkmcnt(6)
v_mfma_f32_32x32x16_bf16 v[88:103], v[144:147], v[120:123], v[88:103]
ds_read_b128 v[140:143], v175 offset:17408
s_waitcnt lgkmcnt(4)
v_mfma_f32_32x32x16_bf16 v[24:39], v[148:151], v[124:127], v[24:39]
s_waitcnt vmcnt(21)
s_waitcnt lgkmcnt(0)
s_barrier
ds_read_b64_tr_b16 v[144:145], v170 offset:49152
ds_read_b64_tr_b16 v[146:147], v170 offset:50176
v_mfma_f32_32x32x16_bf16 v[40:55], v[148:151], v[128:131], v[40:55]
ds_read_b128 v[104:107], v162 offset:32768
ds_read_b128 v[108:111], v162 offset:36864
v_mfma_f32_32x32x16_bf16 v[56:71], v[148:151], v[132:135], v[56:71]
ds_read_b128 v[112:115], v162 offset:40960
ds_read_b128 v[116:119], v162 offset:45056
v_mfma_f32_32x32x16_bf16 v[72:87], v[148:151], v[136:139], v[72:87]
ds_read_b128 v[120:123], v172 offset:19584
s_add_u32 m0, s47, 0
s_add_u32 s101, s93, 884736
buffer_load_dwordx4 v240, s[20:23], s101 offen offset:0  lds
v_mfma_f32_32x32x16_bf16 v[88:103], v[148:151], v[140:143], v[88:103]
buffer_load_dwordx4 v241, s[20:23], s101 offen offset:1024  lds
buffer_load_dwordx4 v242, s[20:23], s101 offen offset:2048  lds
s_waitcnt lgkmcnt(4)
v_mfma_f32_32x32x16_bf16 v[24:39], v[144:147], v[104:107], v[24:39]
ds_read_b64_tr_b16 v[148:149], v170 offset:53248
ds_read_b64_tr_b16 v[150:151], v170 offset:54272
s_waitcnt lgkmcnt(5)
v_mfma_f32_32x32x16_bf16 v[40:55], v[144:147], v[108:111], v[40:55]
ds_read_b128 v[124:127], v163 offset:32768
ds_read_b128 v[128:131], v163 offset:36864
s_waitcnt lgkmcnt(6)
v_mfma_f32_32x32x16_bf16 v[56:71], v[144:147], v[112:115], v[56:71]
ds_read_b128 v[132:135], v163 offset:40960
ds_read_b128 v[136:139], v163 offset:45056
s_waitcnt lgkmcnt(7)
v_mfma_f32_32x32x16_bf16 v[72:87], v[144:147], v[116:119], v[72:87]
ds_read_b128 v[140:143], v173 offset:19584
buffer_load_dwordx4 v243, s[20:23], s101 offen offset:3072  lds
s_waitcnt lgkmcnt(7)
v_mfma_f32_32x32x16_bf16 v[88:103], v[144:147], v[120:123], v[88:103]
s_add_u32 m0, s47, 4096
s_add_u32 s101, s94, 1105920
buffer_load_dwordx4 v240, s[20:23], s101 offen offset:0  lds
buffer_load_dwordx4 v241, s[20:23], s101 offen offset:1024  lds
s_waitcnt lgkmcnt(4)
v_mfma_f32_32x32x16_bf16 v[24:39], v[148:151], v[124:127], v[24:39]
ds_read_b64_tr_b16 v[144:145], v170 offset:57344
ds_read_b64_tr_b16 v[146:147], v170 offset:58368
s_waitcnt lgkmcnt(5)
v_mfma_f32_32x32x16_bf16 v[40:55], v[148:151], v[128:131], v[40:55]
ds_read_b128 v[104:107], v164 offset:32768
ds_read_b128 v[108:111], v164 offset:36864
s_waitcnt lgkmcnt(6)
v_mfma_f32_32x32x16_bf16 v[56:71], v[148:151], v[132:135], v[56:71]
ds_read_b128 v[112:115], v164 offset:40960
ds_read_b128 v[116:119], v164 offset:45056
s_waitcnt lgkmcnt(7)
v_mfma_f32_32x32x16_bf16 v[72:87], v[148:151], v[136:139], v[72:87]
ds_read_b128 v[120:123], v174 offset:19584
buffer_load_dwordx4 v242, s[20:23], s101 offen offset:2048  lds
s_waitcnt lgkmcnt(7)
v_mfma_f32_32x32x16_bf16 v[88:103], v[148:151], v[140:143], v[88:103]
buffer_load_dwordx4 v243, s[20:23], s101 offen offset:3072  lds
s_waitcnt lgkmcnt(4)
v_mfma_f32_32x32x16_bf16 v[24:39], v[144:147], v[104:107], v[24:39]
ds_read_b64_tr_b16 v[148:149], v170 offset:61440
ds_read_b64_tr_b16 v[150:151], v170 offset:62464
s_waitcnt lgkmcnt(5)
v_mfma_f32_32x32x16_bf16 v[40:55], v[144:147], v[108:111], v[40:55]
ds_read_b128 v[124:127], v165 offset:32768
s_waitcnt lgkmcnt(5)
v_mfma_f32_32x32x16_bf16 v[56:71], v[144:147], v[112:115], v[56:71]
ds_read_b128 v[128:131], v165 offset:36864
ds_read_b128 v[132:135], v165 offset:40960
s_waitcnt lgkmcnt(6)
v_mfma_f32_32x32x16_bf16 v[72:87], v[144:147], v[116:119], v[72:87]
ds_read_b128 v[136:139], v165 offset:45056
s_waitcnt lgkmcnt(6)
v_mfma_f32_32x32x16_bf16 v[88:103], v[144:147], v[120:123], v[88:103]
ds_read_b128 v[140:143], v175 offset:19584
s_waitcnt lgkmcnt(4)
v_mfma_f32_32x32x16_bf16 v[24:39], v[148:151], v[124:127], v[24:39]
s_waitcnt lgkmcnt(3)
v_mfma_f32_32x32x16_bf16 v[40:55], v[148:151], v[128:131], v[40:55]
s_waitcnt lgkmcnt(2)
v_mfma_f32_32x32x16_bf16 v[56:71], v[148:151], v[132:135], v[56:71]
s_waitcnt lgkmcnt(1)
v_mfma_f32_32x32x16_bf16 v[72:87], v[148:151], v[136:139], v[72:87]
s_waitcnt lgkmcnt(0)
v_mfma_f32_32x32x16_bf16 v[88:103], v[148:151], v[140:143], v[88:103]
s_waitcnt vmcnt(24)
v_cmp_ne_u32 vcc, s7, v202
Lc_13:
v_cmp_ne_u32 s[52:53], s7, v186
s_or_b64 vcc, vcc, s[52:53]
v_cmp_ne_u32 s[52:53], s7, v190
s_or_b64 vcc, vcc, s[52:53]
v_cmp_ne_u32 s[52:53], s7, v194
s_or_b64 vcc, vcc, s[52:53]
v_cmp_ne_u32 s[52:53], s7, v198
s_or_b64 vcc, vcc, s[52:53]
s_cbranch_vccz Lo_14
s_sub_u32 s91, s91, 1
s_cbranch_scc1 Lend
buffer_load_dwordx4 v[184:187], v222, s[32:35], s55 offen offset:0 sc1
buffer_load_dwordx4 v[188:191], v222, s[32:35], s55 offen offset:512 sc1
buffer_load_dwordx4 v[192:195], v222, s[32:35], s55 offen offset:1024 sc1
buffer_load_dwordx4 v[196:199], v222, s[32:35], s55 offen offset:1536 sc1
s_mov_b32 s3, 1703936
buffer_load_dwordx4 v[200:203], v223, s[32:35], s3 offen sc1
s_waitcnt vmcnt(0)
s_waitcnt vmcnt(0)
v_cmp_ne_u32 vcc, s7, v202
s_branch Lc_13
Lo_14:
s_getreg_b32 s3, hwreg(HW_REG_XCC_ID, 0, 4)
v_cmp_ne_u32 vcc, s3, v187
v_cmp_ne_u32 s[52:53], s3, v191
s_or_b64 vcc, vcc, s[52:53]
v_cmp_ne_u32 s[52:53], s3, v195
s_or_b64 vcc, vcc, s[52:53]
v_cmp_ne_u32 s[52:53], s3, v199
s_or_b64 vcc, vcc, s[52:53]
s_cselect_b32 s90, 0, 1
v_mov_b32_dpp v4, v88 quad_perm:[0,0,2,2] row_mask:0xf bank_mask:0xf
v_mov_b32_dpp v5, v89 quad_perm:[0,0,2,2] row_mask:0xf bank_mask:0xf
v_mov_b32_dpp v6, v90 quad_perm:[0,0,2,2] row_mask:0xf bank_mask:0xf
v_mov_b32_dpp v7, v91 quad_perm:[0,0,2,2] row_mask:0xf bank_mask:0xf
v_mov_b32_dpp v8, v92 quad_perm:[0,0,2,2] row_mask:0xf bank_mask:0xf
v_mov_b32_dpp v9, v93 quad_perm:[0,0,2,2] row_mask:0xf bank_mask:0xf
v_mov_b32_dpp v10, v94 quad_perm:[0,0,2,2] row_mask:0xf bank_mask:0xf
v_mov_b32_dpp v11, v95 quad_perm:[0,0,2,2] row_mask:0xf bank_mask:0xf
v_mov_b32_dpp v12, v96 quad_perm:[0,0,2,2] row_mask:0xf bank_mask:0xf
v_mov_b32_dpp v13, v97 quad_perm:[0,0,2,2] row_mask:0xf bank_mask:0xf
v_mov_b32_dpp v14, v98 quad_perm:[0,0,2,2] row_mask:0xf bank_mask:0xf
v_mov_b32_dpp v15, v99 quad_perm:[0,0,2,2] row_mask:0xf bank_mask:0xf
v_mov_b32_dpp v16, v100 quad_perm:[0,0,2,2] row_mask:0xf bank_mask:0xf
v_mov_b32_dpp v17, v101 quad_perm:[0,0,2,2] row_mask:0xf bank_mask:0xf
v_mov_b32_dpp v18, v102 quad_perm:[0,0,2,2] row_mask:0xf bank_mask:0xf
v_mov_b32_dpp v19, v103 quad_perm:[0,0,2,2] row_mask:0xf bank_mask:0xf
s_cmp_lg_u32 s41, 0
s_cbranch_scc1 Lh_15
v_pk_mul_f32 v[176:177], v[4:5], v[200:201] op_sel:[0,1] op_sel_hi:[1,1]
v_pk_fma_f32 v[176:177], v[88:89], v[200:201], v[176:177] op_sel:[0,0,0] op_sel_hi:[1,0,1]
v_cvt_pk_bf16_f32 v204, v176, v177
v_pk_mul_f32 v[178:179], v[6:7], v[200:201] op_sel:[0,1] op_sel_hi:[1,1]
v_pk_fma_f32 v[178:179], v[90:91], v[200:201], v[178:179] op_sel:[0,0,0] op_sel_hi:[1,0,1]
v_cvt_pk_bf16_f32 v205, v178, v179
v_pk_mul_f32 v[180:181], v[8:9], v[200:201] op_sel:[0,1] op_sel_hi:[1,1]
v_pk_fma_f32 v[180:181], v[92:93], v[200:201], v[180:181] op_sel:[0,0,0] op_sel_hi:[1,0,1]
v_cvt_pk_bf16_f32 v206, v180, v181
v_pk_mul_f32 v[182:183], v[10:11], v[200:201] op_sel:[0,1] op_sel_hi:[1,1]
v_pk_fma_f32 v[182:183], v[94:95], v[200:201], v[182:183] op_sel:[0,0,0] op_sel_hi:[1,0,1]
v_cvt_pk_bf16_f32 v207, v182, v183
v_pk_mul_f32 v[176:177], v[12:13], v[200:201] op_sel:[0,1] op_sel_hi:[1,1]
v_pk_fma_f32 v[176:177], v[96:97], v[200:201], v[176:177] op_sel:[0,0,0] op_sel_hi:[1,0,1]
v_cvt_pk_bf16_f32 v208, v176, v177
v_pk_mul_f32 v[178:179], v[14:15], v[200:201] op_sel:[0,1] op_sel_hi:[1,1]
v_pk_fma_f32 v[178:179], v[98:99], v[200:201], v[178:179] op_sel:[0,0,0] op_sel_hi:[1,0,1]
v_cvt_pk_bf16_f32 v209, v178, v179
v_pk_mul_f32 v[180:181], v[16:17], v[200:201] op_sel:[0,1] op_sel_hi:[1,1]
v_pk_fma_f32 v[180:181], v[100:101], v[200:201], v[180:181] op_sel:[0,0,0] op_sel_hi:[1,0,1]
v_cvt_pk_bf16_f32 v210, v180, v181
v_pk_mul_f32 v[182:183], v[18:19], v[200:201] op_sel:[0,1] op_sel_hi:[1,1]
v_pk_fma_f32 v[182:183], v[102:103], v[200:201], v[182:183] op_sel:[0,0,0] op_sel_hi:[1,0,1]
v_cvt_pk_bf16_f32 v211, v182, v183
s_add_u32 s3, s58, 8704
s_mov_b32 exec_lo, 0xaaaaaaaa
s_mov_b32 exec_hi, 0xaaaaaaaa
buffer_store_dwordx4 v[204:207], v224, s[32:35], s58 offen sc1
buffer_store_dwordx4 v[208:211], v224, s[32:35], s3 offen sc1
s_mov_b64 exec, -1
Lh_15:
v_pk_mul_f32 v[176:177], v[4:5], v[188:189] op_sel:[0,1] op_sel_hi:[1,1]
v_pk_fma_f32 v[176:177], v[40:41], v[188:189], v[176:177] op_sel:[0,0,0] op_sel_hi:[1,0,1]
v_cvt_pk_bf16_f32 v212, v176, v177
v_pk_mul_f32 v[178:179], v[6:7], v[188:189] op_sel:[0,1] op_sel_hi:[1,1]
v_pk_fma_f32 v[178:179], v[42:43], v[188:189], v[178:179] op_sel:[0,0,0] op_sel_hi:[1,0,1]
v_cvt_pk_bf16_f32 v213, v178, v179
v_pk_mul_f32 v[180:181], v[8:9], v[188:189] op_sel:[0,1] op_sel_hi:[1,1]
v_pk_fma_f32 v[180:181], v[44:45], v[188:189], v[180:181] op_sel:[0,0,0] op_sel_hi:[1,0,1]
v_cvt_pk_bf16_f32 v214, v180, v181
v_pk_mul_f32 v[182:183], v[10:11], v[188:189] op_sel:[0,1] op_sel_hi:[1,1]
v_pk_fma_f32 v[182:183], v[46:47], v[188:189], v[182:183] op_sel:[0,0,0] op_sel_hi:[1,0,1]
v_cvt_pk_bf16_f32 v215, v182, v183
v_pk_mul_f32 v[176:177], v[12:13], v[188:189] op_sel:[0,1] op_sel_hi:[1,1]
v_pk_fma_f32 v[176:177], v[48:49], v[188:189], v[176:177] op_sel:[0,0,0] op_sel_hi:[1,0,1]
v_cvt_pk_bf16_f32 v216, v176, v177
v_pk_mul_f32 v[178:179], v[14:15], v[188:189] op_sel:[0,1] op_sel_hi:[1,1]
v_pk_fma_f32 v[178:179], v[50:51], v[188:189], v[178:179] op_sel:[0,0,0] op_sel_hi:[1,0,1]
v_cvt_pk_bf16_f32 v217, v178, v179
v_pk_mul_f32 v[180:181], v[16:17], v[188:189] op_sel:[0,1] op_sel_hi:[1,1]
v_pk_fma_f32 v[180:181], v[52:53], v[188:189], v[180:181] op_sel:[0,0,0] op_sel_hi:[1,0,1]
v_cvt_pk_bf16_f32 v218, v180, v181
v_pk_mul_f32 v[182:183], v[18:19], v[188:189] op_sel:[0,1] op_sel_hi:[1,1]
v_pk_fma_f32 v[182:183], v[54:55], v[188:189], v[182:183] op_sel:[0,0,0] op_sel_hi:[1,0,1]
v_cvt_pk_bf16_f32 v219, v182, v183
buffer_store_dwordx4 v[212:215], v220, s[32:35], s59 offen offset:512 sc1
buffer_store_dwordx4 v[216:219], v221, s[32:35], s59 offen offset:512 sc1
v_pk_mul_f32 v[176:177], v[4:5], v[184:185] op_sel:[0,1] op_sel_hi:[1,1]
v_pk_fma_f32 v[176:177], v[24:25], v[184:185], v[176:177] op_sel:[0,0,0] op_sel_hi:[1,0,1]
v_cvt_pk_bf16_f32 v204, v176, v177
v_pk_mul_f32 v[178:179], v[6:7], v[184:185] op_sel:[0,1] op_sel_hi:[1,1]
v_pk_fma_f32 v[178:179], v[26:27], v[184:185], v[178:179] op_sel:[0,0,0] op_sel_hi:[1,0,1]
v_cvt_pk_bf16_f32 v205, v178, v179
v_pk_mul_f32 v[180:181], v[8:9], v[184:185] op_sel:[0,1] op_sel_hi:[1,1]
v_pk_fma_f32 v[180:181], v[28:29], v[184:185], v[180:181] op_sel:[0,0,0] op_sel_hi:[1,0,1]
v_cvt_pk_bf16_f32 v206, v180, v181
v_pk_mul_f32 v[182:183], v[10:11], v[184:185] op_sel:[0,1] op_sel_hi:[1,1]
v_pk_fma_f32 v[182:183], v[30:31], v[184:185], v[182:183] op_sel:[0,0,0] op_sel_hi:[1,0,1]
v_cvt_pk_bf16_f32 v207, v182, v183
v_pk_mul_f32 v[176:177], v[12:13], v[184:185] op_sel:[0,1] op_sel_hi:[1,1]
v_pk_fma_f32 v[176:177], v[32:33], v[184:185], v[176:177] op_sel:[0,0,0] op_sel_hi:[1,0,1]
v_cvt_pk_bf16_f32 v208, v176, v177
v_pk_mul_f32 v[178:179], v[14:15], v[184:185] op_sel:[0,1] op_sel_hi:[1,1]
v_pk_fma_f32 v[178:179], v[34:35], v[184:185], v[178:179] op_sel:[0,0,0] op_sel_hi:[1,0,1]
v_cvt_pk_bf16_f32 v209, v178, v179
v_pk_mul_f32 v[180:181], v[16:17], v[184:185] op_sel:[0,1] op_sel_hi:[1,1]
v_pk_fma_f32 v[180:181], v[36:37], v[184:185], v[180:181] op_sel:[0,0,0] op_sel_hi:[1,0,1]
v_cvt_pk_bf16_f32 v210, v180, v181
v_pk_mul_f32 v[182:183], v[18:19], v[184:185] op_sel:[0,1] op_sel_hi:[1,1]
v_pk_fma_f32 v[182:183], v[38:39], v[184:185], v[182:183] op_sel:[0,0,0] op_sel_hi:[1,0,1]
v_cvt_pk_bf16_f32 v211, v182, v183
buffer_store_dwordx4 v[204:207], v220, s[32:35], s59 offen offset:0 sc1
buffer_store_dwordx4 v[208:211], v221, s[32:35], s59 offen offset:0 sc1
v_pk_mul_f32 v[176:177], v[4:5], v[196:197] op_sel:[0,1] op_sel_hi:[1,1]
v_pk_fma_f32 v[176:177], v[72:73], v[196:197], v[176:177] op_sel:[0,0,0] op_sel_hi:[1,0,1]
v_cvt_pk_bf16_f32 v212, v176, v177
v_pk_mul_f32 v[178:179], v[6:7], v[196:197] op_sel:[0,1] op_sel_hi:[1,1]
v_pk_fma_f32 v[178:179], v[74:75], v[196:197], v[178:179] op_sel:[0,0,0] op_sel_hi:[1,0,1]
v_cvt_pk_bf16_f32 v213, v178, v179
v_pk_mul_f32 v[180:181], v[8:9], v[196:197] op_sel:[0,1] op_sel_hi:[1,1]
v_pk_fma_f32 v[180:181], v[76:77], v[196:197], v[180:181] op_sel:[0,0,0] op_sel_hi:[1,0,1]
v_cvt_pk_bf16_f32 v214, v180, v181
v_pk_mul_f32 v[182:183], v[10:11], v[196:197] op_sel:[0,1] op_sel_hi:[1,1]
v_pk_fma_f32 v[182:183], v[78:79], v[196:197], v[182:183] op_sel:[0,0,0] op_sel_hi:[1,0,1]
v_cvt_pk_bf16_f32 v215, v182, v183
v_pk_mul_f32 v[176:177], v[12:13], v[196:197] op_sel:[0,1] op_sel_hi:[1,1]
v_pk_fma_f32 v[176:177], v[80:81], v[196:197], v[176:177] op_sel:[0,0,0] op_sel_hi:[1,0,1]
v_cvt_pk_bf16_f32 v216, v176, v177
v_pk_mul_f32 v[178:179], v[14:15], v[196:197] op_sel:[0,1] op_sel_hi:[1,1]
v_pk_fma_f32 v[178:179], v[82:83], v[196:197], v[178:179] op_sel:[0,0,0] op_sel_hi:[1,0,1]
v_cvt_pk_bf16_f32 v217, v178, v179
v_pk_mul_f32 v[180:181], v[16:17], v[196:197] op_sel:[0,1] op_sel_hi:[1,1]
v_pk_fma_f32 v[180:181], v[84:85], v[196:197], v[180:181] op_sel:[0,0,0] op_sel_hi:[1,0,1]
v_cvt_pk_bf16_f32 v218, v180, v181
v_pk_mul_f32 v[182:183], v[18:19], v[196:197] op_sel:[0,1] op_sel_hi:[1,1]
v_pk_fma_f32 v[182:183], v[86:87], v[196:197], v[182:183] op_sel:[0,0,0] op_sel_hi:[1,0,1]
v_cvt_pk_bf16_f32 v219, v182, v183
buffer_store_dwordx4 v[212:215], v220, s[32:35], s59 offen offset:1536 sc1
buffer_store_dwordx4 v[216:219], v221, s[32:35], s59 offen offset:1536 sc1
v_pk_mul_f32 v[176:177], v[4:5], v[192:193] op_sel:[0,1] op_sel_hi:[1,1]
v_pk_fma_f32 v[176:177], v[56:57], v[192:193], v[176:177] op_sel:[0,0,0] op_sel_hi:[1,0,1]
v_cvt_pk_bf16_f32 v204, v176, v177
v_pk_mul_f32 v[178:179], v[6:7], v[192:193] op_sel:[0,1] op_sel_hi:[1,1]
v_pk_fma_f32 v[178:179], v[58:59], v[192:193], v[178:179] op_sel:[0,0,0] op_sel_hi:[1,0,1]
v_cvt_pk_bf16_f32 v205, v178, v179
v_pk_mul_f32 v[180:181], v[8:9], v[192:193] op_sel:[0,1] op_sel_hi:[1,1]
v_pk_fma_f32 v[180:181], v[60:61], v[192:193], v[180:181] op_sel:[0,0,0] op_sel_hi:[1,0,1]
v_cvt_pk_bf16_f32 v206, v180, v181
v_pk_mul_f32 v[182:183], v[10:11], v[192:193] op_sel:[0,1] op_sel_hi:[1,1]
v_pk_fma_f32 v[182:183], v[62:63], v[192:193], v[182:183] op_sel:[0,0,0] op_sel_hi:[1,0,1]
v_cvt_pk_bf16_f32 v207, v182, v183
v_pk_mul_f32 v[176:177], v[12:13], v[192:193] op_sel:[0,1] op_sel_hi:[1,1]
v_pk_fma_f32 v[176:177], v[64:65], v[192:193], v[176:177] op_sel:[0,0,0] op_sel_hi:[1,0,1]
v_cvt_pk_bf16_f32 v208, v176, v177
v_pk_mul_f32 v[178:179], v[14:15], v[192:193] op_sel:[0,1] op_sel_hi:[1,1]
v_pk_fma_f32 v[178:179], v[66:67], v[192:193], v[178:179] op_sel:[0,0,0] op_sel_hi:[1,0,1]
v_cvt_pk_bf16_f32 v209, v178, v179
v_pk_mul_f32 v[180:181], v[16:17], v[192:193] op_sel:[0,1] op_sel_hi:[1,1]
v_pk_fma_f32 v[180:181], v[68:69], v[192:193], v[180:181] op_sel:[0,0,0] op_sel_hi:[1,0,1]
v_cvt_pk_bf16_f32 v210, v180, v181
v_pk_mul_f32 v[182:183], v[18:19], v[192:193] op_sel:[0,1] op_sel_hi:[1,1]
v_pk_fma_f32 v[182:183], v[70:71], v[192:193], v[182:183] op_sel:[0,0,0] op_sel_hi:[1,0,1]
v_cvt_pk_bf16_f32 v211, v182, v183
buffer_store_dwordx4 v[204:207], v220, s[32:35], s59 offen offset:1024 sc1
buffer_store_dwordx4 v[208:211], v221, s[32:35], s59 offen offset:1024 sc1
v_lshlrev_b32 v3, 7, v0
s_lshl_b32 s40, s5, 2
s_add_u32 s40, s40, s6
s_lshl_b32 s40, s40, 13
s_lshl_b32 s47, s6, 13
v_add_u32 v1, s47, v248
v_add_u32 v2, 0x10000, v1
v_mov_b32 v4, 0x3f803f80
v_mov_b32 v5, 0x3f803f80
v_mov_b32 v6, 0x3f803f80
v_mov_b32 v7, 0x3f803f80
s_waitcnt vmcnt(31)
ds_read_b64_tr_b16 a[0:1], v2 offset:0
ds_read_b64_tr_b16 a[2:3], v2 offset:256
s_waitcnt vmcnt(30)
ds_read_b64_tr_b16 a[4:5], v2 offset:1024
ds_read_b64_tr_b16 a[6:7], v2 offset:1280
s_waitcnt vmcnt(29)
ds_read_b64_tr_b16 a[8:9], v2 offset:2048
ds_read_b64_tr_b16 a[10:11], v2 offset:2304
s_waitcnt vmcnt(28)
ds_read_b64_tr_b16 a[12:13], v2 offset:3072
ds_read_b64_tr_b16 a[14:15], v2 offset:3328
s_waitcnt vmcnt(27)
ds_read_b64_tr_b16 a[16:17], v2 offset:4096
ds_read_b64_tr_b16 a[18:19], v2 offset:4352
s_waitcnt vmcnt(26)
ds_read_b64_tr_b16 a[20:21], v2 offset:5120
ds_read_b64_tr_b16 a[22:23], v2 offset:5376
s_waitcnt vmcnt(25)
ds_read_b64_tr_b16 a[24:25], v2 offset:6144
ds_read_b64_tr_b16 a[26:27], v2 offset:6400
s_waitcnt vmcnt(24)
ds_read_b64_tr_b16 a[28:29], v2 offset:7168
ds_read_b64_tr_b16 a[30:31], v2 offset:7424
s_waitcnt vmcnt(23)
ds_read_b64_tr_b16 a[32:33], v2 offset:32768
ds_read_b64_tr_b16 a[34:35], v2 offset:33024
s_waitcnt vmcnt(22)
ds_read_b64_tr_b16 a[36:37], v2 offset:33792
ds_read_b64_tr_b16 a[38:39], v2 offset:34048
s_waitcnt vmcnt(21)
ds_read_b64_tr_b16 a[40:41], v2 offset:34816
ds_read_b64_tr_b16 a[42:43], v2 offset:35072
s_waitcnt vmcnt(20)
ds_read_b64_tr_b16 a[44:45], v2 offset:35840
ds_read_b64_tr_b16 a[46:47], v2 offset:36096
s_waitcnt vmcnt(19)
ds_read_b64_tr_b16 a[48:49], v2 offset:36864
ds_read_b64_tr_b16 a[50:51], v2 offset:37120
s_waitcnt vmcnt(18)
ds_read_b64_tr_b16 a[52:53], v2 offset:37888
ds_read_b64_tr_b16 a[54:55], v2 offset:38144
s_waitcnt vmcnt(17)
ds_read_b64_tr_b16 a[56:57], v2 offset:38912
ds_read_b64_tr_b16 a[58:59], v2 offset:39168
s_waitcnt vmcnt(16)
ds_read_b64_tr_b16 a[60:61], v2 offset:39936
ds_read_b64_tr_b16 a[62:63], v2 offset:40192
s_waitcnt vmcnt(15)
ds_read_b64_tr_b16 a[64:65], v1 offset:0
ds_read_b64_tr_b16 a[66:67], v1 offset:256
s_waitcnt vmcnt(14)
ds_read_b64_tr_b16 a[68:69], v1 offset:1024
ds_read_b64_tr_b16 a[70:71], v1 offset:1280
s_waitcnt vmcnt(13)
ds_read_b64_tr_b16 a[72:73], v1 offset:2048
ds_read_b64_tr_b16 a[74:75], v1 offset:2304
s_waitcnt vmcnt(12)
ds_read_b64_tr_b16 a[76:77], v1 offset:3072
ds_read_b64_tr_b16 a[78:79], v1 offset:3328
s_waitcnt vmcnt(11)
ds_read_b64_tr_b16 a[80:81], v1 offset:4096
ds_read_b64_tr_b16 a[82:83], v1 offset:4352
s_waitcnt vmcnt(10)
ds_read_b64_tr_b16 a[84:85], v1 offset:5120
ds_read_b64_tr_b16 a[86:87], v1 offset:5376
s_waitcnt vmcnt(9)
ds_read_b64_tr_b16 a[88:89], v1 offset:6144
ds_read_b64_tr_b16 a[90:91], v1 offset:6400
s_waitcnt vmcnt(8)
ds_read_b64_tr_b16 a[92:93], v1 offset:7168
ds_read_b64_tr_b16 a[94:95], v1 offset:7424
s_waitcnt lgkmcnt(0)
s_barrier
s_cmp_ge_u32 s5, 20
s_cbranch_scc1 Lnowo_16
s_cmp_eq_u32 s6, 0
s_cbranch_scc1 Lnowo_16
s_mul_i32 s46, s6, 16
s_add_u32 s46, s46, 16
s_mul_i32 s45, s46, 10240
s_lshl_b32 s47, s97, 7
s_add_u32 s45, s45, s47
s_lshl_b32 s46, s46, 10
s_add_u32 m0, s46, 0
s_add_u32 s101, s45, 0
buffer_load_dwordx4 v244, s[16:19], s101 offen offset:0  lds
buffer_load_dwordx4 v245, s[16:19], s101 offen offset:1024  lds
buffer_load_dwordx4 v246, s[16:19], s101 offen offset:2048  lds
buffer_load_dwordx4 v247, s[16:19], s101 offen offset:3072  lds
s_waitcnt vmcnt(4)
s_branch Lnowo_17
Lnowo_16:
s_waitcnt vmcnt(0)
Lnowo_17:
s_waitcnt vmcnt(63) lgkmcnt(0)
s_barrier
s_cmp_lg_u32 s6, 0
s_cbranch_scc1 Lb_18
s_lshl_b32 s3, s5, 2
s_add_u32 s3, s3, 1736832
v_mov_b32 v255, s7
v_mov_b32 v254, 0
s_mov_b64 exec, 1
s_cmp_eq_u32 s90, 0
s_cbranch_scc1 Lb_19
buffer_store_dword v255, v254, s[32:35], s3 offen
s_mov_b64 exec, -1
s_branch Lb_18
Lb_19:
buffer_wbl2 sc1
s_waitcnt vmcnt(0)
buffer_store_dword v255, v254, s[32:35], s3 offen sc0 sc1
s_mov_b64 exec, -1
Lb_18:
s_branch Lattn
Lhelp:
s_getpc_b64 s[52:53]
Lpc1:
s_sub_u32 s52, s52, Lpc1-Lstart
s_subb_u32 s53, s53, 0
v_lshlrev_b32 v22, 7, v0
s_lshl_b32 s54, s5, 11
s_add_u32 s52, s52, s54
s_addc_u32 s53, s53, 0
s_sub_u32 s54, Lendcode-Lstart-4, s54
s_min_i32 s54, s54, 2047
s_cmp_lg_u32 s6, 0
s_cselect_b32 s54, -1, s54
v_cmp_ge_i32 vcc, s54, v22
s_and_saveexec_b64 s[54:55], vcc
s_cbranch_execz Lnopf1
global_load_dword v252, v22, s[52:53]
Lnopf1:
s_mov_b64 exec, -1
s_load_dwordx2 s[16:17], s[0:1], 16
s_load_dwordx4 s[20:23], s[0:1], 32
s_load_dwordx2 s[28:29], s[0:1], 48
s_sub_u32 s42, s5, 30
s_waitcnt lgkmcnt(0)
s_mov_b32 s14, 2457600
s_mov_b32 s15, 0x20000
s_mov_b64 s[12:13], s[10:11]
s_mov_b32 s10, 2621440
s_mov_b32 s11, 0x20000
s_lshl_b32 s58, s6, 5
s_add_u32 s58, s58, s5
s_lshl_b32 s59, s4, 6
s_add_u32 s59, s59, s58
s_sub_u32 s59, s59, 4
v_lshrrev_b32 v3, 4, v0
v_mul_u32_u24 v2, 1280, v3
v_and_b32 v4, 15, v0
v_lshl_add_u32 v2, v4, 4, v2
s_mul_i32 s3, s59, 5120
s_cmp_lt_i32 s59, 0
s_cselect_b32 s59, 2130706432, s3
s_lshl_b32 s3, s4, 22
s_mov_b32 s34, 4194304
s_mov_b32 s35, 0x20000
s_add_u32 s32, s32, s3
s_addc_u32 s33, s33, 0
s_cmp_ge_u32 s58, 68
s_cbranch_scc1 Ls_20
buffer_load_dwordx4 v[4:7], v2, s[8:11], s59 offen offset:0
buffer_load_dwordx4 v[8:11], v2, s[8:11], s59 offen offset:256
buffer_load_dwordx4 v[12:15], v2, s[8:11], s59 offen offset:512
buffer_load_dwordx4 v[16:19], v2, s[8:11], s59 offen offset:768
buffer_load_dwordx4 v[20:23], v2, s[8:11], s59 offen offset:1024
Ls_20:
s_mov_b32 s3, 1736704
v_mov_b32 v254, 0
buffer_load_dword v255, v254, s[32:35], s3 offen sc1
s_mov_b64 s[24:25], s[22:23]
s_mov_b32 s18, 819200
s_mov_b32 s19, 0x20000
s_mov_b32 s22, 2211840
s_mov_b32 s23, 0x20000
s_mov_b32 s26, 2211840
s_mov_b32 s27, 0x20000
s_mov_b32 s30, 2621440
s_mov_b32 s31, 0x20000
s_lshl_b32 s42, s42, 2
s_add_u32 s42, s42, s6
s_lshl_b32 s42, s42, 13
v_lshlrev_b32 v25, 7, v0
s_lshl_b32 s43, s4, 16
s_add_u32 s43, s43, s42
s_add_u32 s3, s43, 0
buffer_load_dword v40, v25, s[16:19], s3 offen
s_add_u32 s3, s43, 524288
buffer_load_dword v41, v25, s[16:19], s3 offen
s_mul_i32 s98, s5, 205
s_lshr_b32 s98, s98, 11
s_mul_i32 s97, s98, 10
s_sub_u32 s97, s5, s97
s_cmp_ge_u32 s5, 14
s_cselect_b32 s100, 1, 0
s_mul_i32 s99, s100, 14
s_sub_u32 s99, s5, s99
s_lshl_b32 s99, s99, 2
s_add_u32 s99, s99, s6
s_lshl_b32 s93, s99, 6
s_cmp_ge_u32 s99, 54
s_cselect_b32 s93, 2130706432, s93
s_mul_i32 s3, s100, 0
s_sub_u32 s94, s93, s3
s_add_u32 s93, s93, s3
s_sub_u32 s3, s99, 56
s_lshl_b32 s3, s3, 7
s_cmp_ge_u32 s5, 28
s_cselect_b32 s94, s3, s94
s_lshl_b32 s3, s97, 7
s_mul_i32 s95, s6, 81920
s_add_u32 s95, s95, s3
s_cmp_ge_u32 s5, 20
s_cselect_b32 s95, 2130706432, s95
s_mul_i32 s96, s6, 552960
s_add_u32 s96, s96, s3
v_lshrrev_b32 v26, 2, v0
v_mul_u32_u24 v26, 3456, v26
v_and_b32 v27, 3, v0
v_lshl_add_u32 v240, v27, 4, v26
v_add_u32 v241, 54272, v240
v_add_u32 v242, 108544, v240
v_add_u32 v243, 162816, v240
v_lshrrev_b32 v26, 3, v0
v_mul_u32_u24 v244, 1280, v26
v_and_b32 v27, 7, v0
v_bfe_u32 v26, v0, 4, 1
v_lshlrev_b32 v26, 2, v26
v_xor_b32 v27, v27, v26
v_lshl_add_u32 v244, v27, 4, v244
v_add_u32 v245, 9216, v244
v_add_u32 v246, 18432, v244
v_add_u32 v247, 27648, v244
v_and_b32 v248, 16, v0
v_lshlrev_b32 v248, 1, v248
v_and_b32 v26, 1, v0
v_lshl_or_b32 v248, v26, 4, v248
v_and_b32 v26, 2, v0
v_lshl_or_b32 v248, v26, 2, v248
v_lshrrev_b32 v26, 5, v0
v_bfe_u32 v27, v0, 2, 2
v_lshl_or_b32 v26, v26, 3, v27
v_lshl_add_u32 v249, v26, 7, v248
v_lshl_add_u32 v248, v26, 6, v248
v_lshrrev_b32 v27, 1, v27
v_lshl_add_u32 v249, v27, 6, v249
s_mov_b32 s91, 0x100000
s_waitcnt vmcnt(2)
v_readfirstlane_b32 s7, v255
s_add_u32 s7, s7, 1
s_cmp_ge_u32 s58, 68
s_cbranch_scc1 Ls_21
s_mov_b32 s59, 0x3f803f80
s_waitcnt vmcnt(2)
v_dot2_f32_bf16 v28, v4, s59, 0
v_dot2_f32_bf16 v29, v4, v4, 0
v_dot2_f32_bf16 v28, v5, s59, v28
v_dot2_f32_bf16 v29, v5, v5, v29
v_dot2_f32_bf16 v28, v6, s59, v28
v_dot2_f32_bf16 v29, v6, v6, v29
v_dot2_f32_bf16 v28, v7, s59, v28
v_dot2_f32_bf16 v29, v7, v7, v29
v_dot2_f32_bf16 v28, v8, s59, v28
v_dot2_f32_bf16 v29, v8, v8, v29
v_dot2_f32_bf16 v28, v9, s59, v28
v_dot2_f32_bf16 v29, v9, v9, v29
v_dot2_f32_bf16 v28, v10, s59, v28
v_dot2_f32_bf16 v29, v10, v10, v29
v_dot2_f32_bf16 v28, v11, s59, v28
v_dot2_f32_bf16 v29, v11, v11, v29
v_dot2_f32_bf16 v28, v12, s59, v28
v_dot2_f32_bf16 v29, v12, v12, v29
v_dot2_f32_bf16 v28, v13, s59, v28
v_dot2_f32_bf16 v29, v13, v13, v29
v_dot2_f32_bf16 v28, v14, s59, v28
v_dot2_f32_bf16 v29, v14, v14, v29
v_dot2_f32_bf16 v28, v15, s59, v28
v_dot2_f32_bf16 v29, v15, v15, v29
v_dot2_f32_bf16 v28, v16, s59, v28
v_dot2_f32_bf16 v29, v16, v16, v29
v_dot2_f32_bf16 v28, v17, s59, v28
v_dot2_f32_bf16 v29, v17, v17, v29
v_dot2_f32_bf16 v28, v18, s59, v28
v_dot2_f32_bf16 v29, v18, v18, v29
v_dot2_f32_bf16 v28, v19, s59, v28
v_dot2_f32_bf16 v29, v19, v19, v29
v_dot2_f32_bf16 v28, v20, s59, v28
v_dot2_f32_bf16 v29, v20, v20, v29
v_dot2_f32_bf16 v28, v21, s59, v28
v_dot2_f32_bf16 v29, v21, v21, v29
v_dot2_f32_bf16 v28, v22, s59, v28
v_dot2_f32_bf16 v29, v22, v22, v29
v_dot2_f32_bf16 v28, v23, s59, v28
v_dot2_f32_bf16 v29, v23, v23, v29
s_nop 1
v_add_f32_dpp v28, v28, v28 quad_perm:[1,0,3,2] row_mask:0xf bank_mask:0xf
v_add_f32_dpp v29, v29, v29 quad_perm:[1,0,3,2] row_mask:0xf bank_mask:0xf
s_nop 0
v_add_f32_dpp v28, v28, v28 quad_perm:[2,3,0,1] row_mask:0xf bank_mask:0xf
v_add_f32_dpp v29, v29, v29 quad_perm:[2,3,0,1] row_mask:0xf bank_mask:0xf
s_nop 0
v_add_f32_dpp v28, v28, v28 row_half_mirror row_mask:0xf bank_mask:0xf
v_add_f32_dpp v29, v29, v29 row_half_mirror row_mask:0xf bank_mask:0xf
s_nop 0
v_add_f32_dpp v28, v28, v28 row_mirror row_mask:0xf bank_mask:0xf
v_add_f32_dpp v29, v29, v29 row_mirror row_mask:0xf bank_mask:0xf
v_mul_f32 v28, 0xbacccccd, v28
v_mul_f32 v29, 0x3acccccd, v29
v_fma_f32 v29, -v28, v28, v29
v_max_f32 v29, 0, v29
v_add_f32 v29, 0x3727c5ac, v29
v_rsq_f32 v32, v29
v_mov_b32 v34, s7
s_getreg_b32 s59, hwreg(HW_REG_XCC_ID, 0, 4)
v_mov_b32 v35, s59
v_mul_f32 v33, v28, v32
v_lshlrev_b32 v3, 4, v3
s_lshl_b32 s58, s58, 6
s_add_u32 s58, s58, 1703936
s_mov_b32 exec_lo, 0x00010001
s_mov_b32 exec_hi, 0x00010001
buffer_store_dwordx4 v[32:35], v3, s[32:35], s58 offen sc1
s_mov_b64 exec, -1
Ls_21:
s_add_u32 s3, s43, 0
buffer_load_dword v44, v25, s[20:23], s3 offen
s_add_u32 s3, s43, 524288
buffer_load_dword v45, v25, s[20:23], s3 offen
s_add_u32 s3, s43, 1048576
buffer_load_dword v46, v25, s[20:23], s3 offen
s_add_u32 s3, s43, 1572864
buffer_load_dword v47, v25, s[20:23], s3 offen
s_add_u32 s3, s43, 2097152
buffer_load_dword v48, v25, s[20:23], s3 offen
s_add_u32 s3, s43, 0
buffer_load_dword v49, v25, s[24:27], s3 offen
s_add_u32 s3, s43, 524288
buffer_load_dword v50, v25, s[24:27], s3 offen
s_add_u32 s3, s43, 1048576
buffer_load_dword v51, v25, s[24:27], s3 offen
s_add_u32 s3, s43, 1572864
buffer_load_dword v52, v25, s[24:27], s3 offen
s_add_u32 s3, s43, 2097152
buffer_load_dword v53, v25, s[24:27], s3 offen
s_waitcnt vmcnt(0)
Lattn:
s_nop 7
s_nop 7
s_lshr_b32 s40, s5, 2
s_and_b32 s41, s5, 3
s_lshl_b32 s41, s41, 2
s_add_u32 s41, s41, s6
s_mul_i32 s42, s41, 21760
s_lshl_b32 s43, s40, 9
s_add_u32 s42, s42, s43
s_mul_i32 s44, s6, 20480
s_add_u32 s44, s44, 81920
v_lshlrev_b32 v230, 4, v0
v_and_b32 v220, 15, v0
v_lshrrev_b32 v221, 5, v0
v_lshrrev_b32 v222, 3, v0
v_mul_u32_u24 v222, 1280, v222
v_lshrrev_b32 v223, 4, v0
v_and_b32 v224, 7, v0
v_xor_b32 v223, v223, v224
v_lshl_add_u32 v234, v223, 4, v222
v_xor_b32 v235, 64, v234
v_lshl_add_u32 v220, v221, 4, v220
v_lshlrev_b32 v221, 4, v220
v_bfe_u32 v222, v0, 4, 1
v_mul_u32_u24 v223, 13056, v222
v_add_u32 v228, v223, v221
v_lshl_add_u32 v229, v222, 3, v221
v_mul_u32_u24 v223, 2304, v222
v_add3_u32 v231, v223, v221, s44
v_add_u32 v232, s44, v229
s_add_u32 s52, s42, 256
s_add_u32 s53, s52, 4352
s_add_u32 s54, s52, 8704
s_or_b32 s48, s40, s4
s_lshl_b32 s55, s4, 1
s_add_u32 s55, s55, s98
s_lshl_b32 s55, s55, 2
s_add_u32 s55, s55, s6
s_mul_i32 s55, s55, 40960
s_lshl_b32 s56, s97, 7
s_add_u32 s55, s55, s56
s_cmp_ge_u32 s5, 20
s_cselect_b32 s55, 2130706432, s55
s_mul_i32 s56, s6, 8192
s_mov_b32 s57, s44
s_and_b32 s45, s5, 3
s_lshl_b32 s45, s45, 1
s_lshl_b32 s92, 5248005, s45
s_lshl_b32 s45, s92, 1
s_or_b32 s46, s45, s92
s_cmp_ge_u32 s40, 4
s_cselect_b32 s92, s45, s92
s_cmp_eq_u32 s40, 4
s_cselect_b32 s92, s46, s92
s_cmp_ge_u32 s5, 20
s_cbranch_scc1 Lnowo_22
s_cmp_eq_u32 s6, 0
s_cbranch_scc1 Lnowo_22
s_mul_i32 s46, s6, 16
s_add_u32 s46, s46, 16
s_mul_i32 s45, s46, 10240
s_lshl_b32 s47, s97, 7
s_add_u32 s45, s45, s47
s_lshl_b32 s46, s46, 10
s_add_u32 m0, s46, 4096
s_add_u32 s101, s45, 40960
buffer_load_dwordx4 v244, s[16:19], s101 offen offset:0  lds
buffer_load_dwordx4 v245, s[16:19], s101 offen offset:1024  lds
buffer_load_dwordx4 v246, s[16:19], s101 offen offset:2048  lds
buffer_load_dwordx4 v247, s[16:19], s101 offen offset:3072  lds
s_add_u32 m0, s46, 8192
s_add_u32 s101, s45, 81920
buffer_load_dwordx4 v244, s[16:19], s101 offen offset:0  lds
buffer_load_dwordx4 v245, s[16:19], s101 offen offset:1024  lds
buffer_load_dwordx4 v246, s[16:19], s101 offen offset:2048  lds
buffer_load_dwordx4 v247, s[16:19], s101 offen offset:3072  lds
s_add_u32 m0, s46, 12288
s_add_u32 s101, s45, 122880
buffer_load_dwordx4 v244, s[16:19], s101 offen offset:0  lds
buffer_load_dwordx4 v245, s[16:19], s101 offen offset:1024  lds
buffer_load_dwordx4 v246, s[16:19], s101 offen offset:2048  lds
buffer_load_dwordx4 v247, s[16:19], s101 offen offset:3072  lds
Lnowo_22:
s_cmp_lg_u32 s6, 0
s_cbranch_scc1 La_24
s_mov_b32 s3, 1736832
v_lshlrev_b32 v254, 2, v0
s_mov_b32 exec_lo, s92
s_mov_b32 exec_hi, 0
Lap_25:
s_sub_u32 s91, s91, 1
s_cbranch_scc1 Lend
buffer_load_dword v255, v254, s[32:35], s3 offen sc1
Lac_26:
s_waitcnt vmcnt(0)
s_waitcnt vmcnt(0)
v_cmp_ne_u32 vcc, s7, v255
s_cbranch_vccnz Lap_25
s_cmp_lt_u32 s5, 30
s_cbranch_scc1 Lah_27
s_mov_b32 exec_lo, -1
s_mov_b32 s3, 1706248
v_lshlrev_b32 v254, 6, v0
Laq_28:
s_sub_u32 s91, s91, 1
s_cbranch_scc1 Lend
buffer_load_dwordx2 v[252:253], v254, s[32:35], s3 offen sc1
s_waitcnt vmcnt(0)
s_waitcnt vmcnt(0)
v_cmp_ne_u32 vcc, s7, v252
s_cbranch_vccnz Laq_28
s_getreg_b32 s3, hwreg(HW_REG_XCC_ID, 0, 4)
v_cmp_ne_u32 vcc, s3, v253
s_cmp_eq_u64 vcc, 0
s_cselect_b32 s90, 1, 0
Lah_27:
s_mov_b64 exec, -1
s_cmp_lg_u32 s90, 0
s_cbranch_scc1 La_24
buffer_inv sc1
s_waitcnt vmcnt(0)
La_24:
s_waitcnt lgkmcnt(0)
s_barrier
s_mov_b32 exec_hi, 0xffff
s_add_u32 m0, s44, 0
s_add_u32 s45, s42, 348160
buffer_load_dwordx4 v230, s[32:35], s45 offen sc1 lds
s_add_u32 m0, s44, 768
s_add_u32 s45, s42, 352512
buffer_load_dwordx4 v230, s[32:35], s45 offen sc1 lds
s_add_u32 m0, s44, 1536
s_add_u32 s45, s42, 356864
buffer_load_dwordx4 v230, s[32:35], s45 offen sc1 lds
s_add_u32 m0, s44, 2304
s_add_u32 s45, s42, 361216
buffer_load_dwordx4 v230, s[32:35], s45 offen sc1 lds
s_add_u32 m0, s44, 3072
s_add_u32 s45, s42, 365568
buffer_load_dwordx4 v230, s[32:35], s45 offen sc1 lds
s_mov_b64 exec, -1
s_add_u32 s45, s42, 256
s_add_u32 s46, s42, 4608
s_add_u32 s47, s42, 8960
buffer_load_dwordx4 v[8:11], v228, s[32:35], s45 offen sc1
buffer_load_dwordx4 v[12:15], v228, s[32:35], s46 offen sc1
buffer_load_dwordx2 v[16:17], v229, s[32:35], s47 offen sc1
s_mov_b32 exec_hi, 0xffff
s_add_u32 m0, s44, 3840
s_add_u32 s45, s42, 696320
buffer_load_dwordx4 v230, s[32:35], s45 offen sc1 lds
s_add_u32 m0, s44, 4608
s_add_u32 s45, s42, 700672
buffer_load_dwordx4 v230, s[32:35], s45 offen sc1 lds
s_add_u32 m0, s44, 5376
s_add_u32 s45, s42, 705024
buffer_load_dwordx4 v230, s[32:35], s45 offen sc1 lds
s_add_u32 m0, s44, 6144
s_add_u32 s45, s42, 709376
buffer_load_dwordx4 v230, s[32:35], s45 offen sc1 lds
s_add_u32 m0, s44, 6912
s_add_u32 s45, s42, 713728
buffer_load_dwordx4 v230, s[32:35], s45 offen sc1 lds
s_mov_b64 exec, -1
s_lshl_b32 s45, s5, 10
s_add_u32 s45, s45, 1712128
buffer_load_dword v233, v230, s[32:35], s45 offen
v_mfma_f32_32x32x16_bf16 a[224:239], a[0:3], v[4:7], 0
v_mfma_f32_32x32x16_bf16 a[224:239], a[4:7], v[4:7], a[224:239]
v_mfma_f32_32x32x16_bf16 a[224:239], a[8:11], v[4:7], a[224:239]
v_mfma_f32_32x32x16_bf16 a[224:239], a[12:15], v[4:7], a[224:239]
v_mfma_f32_32x32x16_bf16 a[224:239], a[16:19], v[4:7], a[224:239]
v_mfma_f32_32x32x16_bf16 a[224:239], a[20:23], v[4:7], a[224:239]
v_mfma_f32_32x32x16_bf16 a[224:239], a[24:27], v[4:7], a[224:239]
v_mfma_f32_32x32x16_bf16 a[224:239], a[28:31], v[4:7], a[224:239]
v_mfma_f32_32x32x16_bf16 a[224:239], a[32:35], v[4:7], a[224:239]
v_mfma_f32_32x32x16_bf16 a[224:239], a[36:39], v[4:7], a[224:239]
v_mfma_f32_32x32x16_bf16 a[224:239], a[40:43], v[4:7], a[224:239]
v_mfma_f32_32x32x16_bf16 a[224:239], a[44:47], v[4:7], a[224:239]
v_mfma_f32_32x32x16_bf16 a[224:239], a[48:51], v[4:7], a[224:239]
v_mfma_f32_32x32x16_bf16 a[224:239], a[52:55], v[4:7], a[224:239]
v_mfma_f32_32x32x16_bf16 a[224:239], a[56:59], v[4:7], a[224:239]
v_mfma_f32_32x32x16_bf16 a[224:239], a[60:63], v[4:7], a[224:239]
v_mfma_f32_32x32x16_bf16 a[224:239], a[64:67], v[4:7], a[224:239]
v_mfma_f32_32x32x16_bf16 a[224:239], a[68:71], v[4:7], a[224:239]
v_mfma_f32_32x32x16_bf16 a[224:239], a[72:75], v[4:7], a[224:239]
v_mfma_f32_32x32x16_bf16 a[224:239], a[76:79], v[4:7], a[224:239]
v_mfma_f32_32x32x16_bf16 a[224:239], a[80:83], v[4:7], a[224:239]
v_mfma_f32_32x32x16_bf16 a[224:239], a[84:87], v[4:7], a[224:239]
v_mfma_f32_32x32x16_bf16 a[224:239], a[88:91], v[4:7], a[224:239]
v_mfma_f32_32x32x16_bf16 a[224:239], a[92:95], v[4:7], a[224:239]
s_waitcnt vmcnt(9)
ds_read_b128 v[20:23], v231 offset:256
ds_read_b128 v[24:27], v231 offset:1024
ds_read_b64 v[28:29], v232 offset:1792
ds_read_b128 v[32:35], v231 offset:224
ds_read_b128 v[36:39], v231 offset:992
ds_read_b64 v[40:41], v232 offset:1760
ds_read_b128 v[44:47], v231 offset:192
ds_read_b128 v[48:51], v231 offset:960
ds_read_b64 v[52:53], v232 offset:1728
ds_read_b128 v[56:59], v231 offset:160
ds_read_b128 v[60:63], v231 offset:928
ds_read_b64 v[64:65], v232 offset:1696
ds_read_b128 v[68:71], v231 offset:128
s_add_u32 m0, s56, 0
s_add_u32 s101, s95, 0
buffer_load_dwordx4 v244, s[16:19], s101 offen offset:0  lds
ds_read_b128 v[72:75], v231 offset:896
ds_read_b64 v[76:77], v232 offset:1664
ds_read_b128 v[80:83], v231 offset:96
ds_read_b128 v[84:87], v231 offset:864
ds_read_b64 v[88:89], v232 offset:1632
s_waitcnt vmcnt(9) lgkmcnt(15)
v_dot2_f32_bf16 v212, v8, v20, 0
s_waitcnt lgkmcnt(14)
v_dot2_f32_bf16 v213, v8, v32, 0
v_dot2_f32_bf16 v212, v9, v21, v212
v_dot2_f32_bf16 v213, v9, v33, v213
buffer_load_dwordx4 v245, s[16:19], s101 offen offset:1024  lds
v_dot2_f32_bf16 v212, v10, v22, v212
v_dot2_f32_bf16 v213, v10, v34, v213
v_dot2_f32_bf16 v212, v11, v23, v212
v_dot2_f32_bf16 v213, v11, v35, v213
s_waitcnt vmcnt(9)
v_dot2_f32_bf16 v212, v12, v24, v212
s_waitcnt lgkmcnt(13)
v_dot2_f32_bf16 v213, v12, v36, v213
v_dot2_f32_bf16 v212, v13, v25, v212
v_dot2_f32_bf16 v213, v13, v37, v213
v_dot2_f32_bf16 v212, v14, v26, v212
buffer_load_dwordx4 v246, s[16:19], s101 offen offset:2048  lds
v_dot2_f32_bf16 v213, v14, v38, v213
v_dot2_f32_bf16 v212, v15, v27, v212
v_dot2_f32_bf16 v213, v15, v39, v213
s_waitcnt vmcnt(9)
v_dot2_f32_bf16 v212, v16, v28, v212
s_waitcnt lgkmcnt(12)
v_dot2_f32_bf16 v213, v16, v40, v213
v_dot2_f32_bf16 v212, v17, v29, v212
v_dot2_f32_bf16 v213, v17, v41, v213
ds_read_b128 v[92:95], v231 offset:64
ds_read_b128 v[96:99], v231 offset:832
buffer_load_dwordx4 v247, s[16:19], s101 offen offset:3072  lds
ds_read_b64 v[100:101], v232 offset:1600
ds_read_b128 v[104:107], v231 offset:32
ds_read_b128 v[108:111], v231 offset:800
ds_read_b64 v[112:113], v232 offset:1568
s_waitcnt lgkmcnt(15)
v_dot2_f32_bf16 v214, v8, v44, 0
s_waitcnt lgkmcnt(14)
v_dot2_f32_bf16 v215, v8, v56, 0
v_dot2_f32_bf16 v214, v9, v45, v214
v_dot2_f32_bf16 v215, v9, v57, v215
v_dot2_f32_bf16 v214, v10, v46, v214
s_add_u32 m0, s56, 4096
s_add_u32 s101, s95, 40960
buffer_load_dwordx4 v244, s[16:19], s101 offen offset:0  lds
v_dot2_f32_bf16 v215, v10, v58, v215
v_dot2_f32_bf16 v214, v11, v47, v214
v_dot2_f32_bf16 v215, v11, v59, v215
v_dot2_f32_bf16 v214, v12, v48, v214
s_waitcnt lgkmcnt(13)
v_dot2_f32_bf16 v215, v12, v60, v215
v_dot2_f32_bf16 v214, v13, v49, v214
v_dot2_f32_bf16 v215, v13, v61, v215
v_dot2_f32_bf16 v214, v14, v50, v214
v_dot2_f32_bf16 v215, v14, v62, v215
v_dot2_f32_bf16 v214, v15, v51, v214
buffer_load_dwordx4 v245, s[16:19], s101 offen offset:1024  lds
v_dot2_f32_bf16 v215, v15, v63, v215
v_dot2_f32_bf16 v214, v16, v52, v214
s_waitcnt lgkmcnt(12)
v_dot2_f32_bf16 v215, v16, v64, v215
v_dot2_f32_bf16 v214, v17, v53, v214
v_dot2_f32_bf16 v215, v17, v65, v215
s_waitcnt vmcnt(7)
ds_read_b128 v[116:119], v231 offset:4096
ds_read_b128 v[120:123], v231 offset:4864
ds_read_b64 v[124:125], v232 offset:5632
buffer_load_dwordx4 v246, s[16:19], s101 offen offset:2048  lds
ds_read_b128 v[128:131], v231 offset:4064
ds_read_b128 v[132:135], v231 offset:4832
ds_read_b64 v[136:137], v232 offset:5600
s_waitcnt lgkmcnt(15)
v_dot2_f32_bf16 v216, v8, v68, 0
s_waitcnt lgkmcnt(14)
v_dot2_f32_bf16 v217, v8, v80, 0
v_dot2_f32_bf16 v216, v9, v69, v216
v_dot2_f32_bf16 v217, v9, v81, v217
v_dot2_f32_bf16 v216, v10, v70, v216
v_dot2_f32_bf16 v217, v10, v82, v217
buffer_load_dwordx4 v247, s[16:19], s101 offen offset:3072  lds
v_dot2_f32_bf16 v216, v11, v71, v216
v_dot2_f32_bf16 v217, v11, v83, v217
v_dot2_f32_bf16 v216, v12, v72, v216
s_waitcnt lgkmcnt(13)
v_dot2_f32_bf16 v217, v12, v84, v217
v_dot2_f32_bf16 v216, v13, v73, v216
v_dot2_f32_bf16 v217, v13, v85, v217
v_dot2_f32_bf16 v216, v14, v74, v216
v_dot2_f32_bf16 v217, v14, v86, v217
v_dot2_f32_bf16 v216, v15, v75, v216
s_add_u32 m0, s57, 8192
s_add_u32 s101, s94, 1327104
buffer_load_dwordx4 v240, s[20:23], s101 offen offset:0  lds
v_dot2_f32_bf16 v217, v15, v87, v217
v_dot2_f32_bf16 v216, v16, v76, v216
s_waitcnt lgkmcnt(12)
v_dot2_f32_bf16 v217, v16, v88, v217
v_dot2_f32_bf16 v216, v17, v77, v216
v_dot2_f32_bf16 v217, v17, v89, v217
ds_read_b128 v[140:143], v231 offset:4032
ds_read_b128 v[144:147], v231 offset:4800
ds_read_b64 v[148:149], v232 offset:5568
ds_read_b128 v[152:155], v231 offset:4000
buffer_load_dwordx4 v241, s[20:23], s101 offen offset:1024  lds
ds_read_b128 v[156:159], v231 offset:4768
ds_read_b64 v[160:161], v232 offset:5536
s_waitcnt lgkmcnt(15)
v_dot2_f32_bf16 v218, v8, v92, 0
s_waitcnt lgkmcnt(14)
v_dot2_f32_bf16 v219, v8, v104, 0
v_dot2_f32_bf16 v218, v9, v93, v218
v_dot2_f32_bf16 v219, v9, v105, v219
v_dot2_f32_bf16 v218, v10, v94, v218
v_dot2_f32_bf16 v219, v10, v106, v219
v_dot2_f32_bf16 v218, v11, v95, v218
v_dot2_f32_bf16 v219, v11, v107, v219
buffer_load_dwordx4 v242, s[20:23], s101 offen offset:2048  lds
v_dot2_f32_bf16 v218, v12, v96, v218
s_waitcnt lgkmcnt(13)
v_dot2_f32_bf16 v219, v12, v108, v219
v_dot2_f32_bf16 v218, v13, v97, v218
v_dot2_f32_bf16 v219, v13, v109, v219
v_dot2_f32_bf16 v218, v14, v98, v218
v_dot2_f32_bf16 v219, v14, v110, v219
v_dot2_f32_bf16 v218, v15, v99, v218
v_dot2_f32_bf16 v219, v15, v111, v219
v_dot2_f32_bf16 v218, v16, v100, v218
buffer_load_dwordx4 v243, s[20:23], s101 offen offset:3072  lds
s_waitcnt lgkmcnt(12)
v_dot2_f32_bf16 v219, v16, v112, v219
v_dot2_f32_bf16 v218, v17, v101, v218
v_dot2_f32_bf16 v219, v17, v113, v219
ds_read_b128 v[164:167], v231 offset:3968
ds_read_b128 v[168:171], v231 offset:4736
ds_read_b64 v[172:173], v232 offset:5504
ds_read_b128 v[176:179], v231 offset:3936
ds_read_b128 v[180:183], v231 offset:4704
ds_read_b64 v[184:185], v232 offset:5472
s_add_u32 m0, s57, 12288
s_add_u32 s101, s94, 1548288
buffer_load_dwordx4 v240, s[20:23], s101 offen offset:0  lds
ds_read_b128 v[188:191], v231 offset:3904
ds_read_b128 v[192:195], v231 offset:4672
ds_read_b64 v[196:197], v232 offset:5440
ds_read_b128 v[200:203], v231 offset:3872
ds_read_b128 v[204:207], v231 offset:4640
ds_read_b64 v[208:209], v232 offset:5408
s_cmp_lg_u32 s48, 0
s_cbranch_scc1 Lm_29
v_mov_b32 v224, 0xf149f2ca
v_cmp_le_u32 vcc, 2, v220
s_nop 1
v_cndmask_b32 v213, v224, v213, vcc
v_cmp_le_u32 vcc, 4, v220
s_nop 1
v_cndmask_b32 v214, v224, v214, vcc
v_cmp_le_u32 vcc, 6, v220
s_nop 1
v_cndmask_b32 v215, v224, v215, vcc
v_cmp_le_u32 vcc, 8, v220
s_nop 1
v_cndmask_b32 v216, v224, v216, vcc
v_cmp_le_u32 vcc, 10, v220
s_nop 1
v_cndmask_b32 v217, v224, v217, vcc
v_cmp_le_u32 vcc, 12, v220
s_nop 1
v_cndmask_b32 v218, v224, v218, vcc
v_cmp_le_u32 vcc, 14, v220
s_nop 1
v_cndmask_b32 v219, v224, v219, vcc
Lm_29:
v_max3_f32 v224, v212, v213, v214
v_max3_f32 v225, v215, v216, v217
buffer_load_dwordx4 v241, s[20:23], s101 offen offset:1024  lds
v_max3_f32 v224, v224, v218, v219
s_mov_b32 s49, 0x3ea52b5c
v_max_f32 v224, v224, v225
v_mul_f32 v224, 0xbea52b5c, v224
v_fma_f32 v212, v212, s49, v224
v_fma_f32 v213, v213, s49, v224
v_fma_f32 v214, v214, s49, v224
v_fma_f32 v215, v215, s49, v224
v_fma_f32 v216, v216, s49, v224
v_fma_f32 v217, v217, s49, v224
v_fma_f32 v218, v218, s49, v224
v_fma_f32 v219, v219, s49, v224
v_exp_f32 v212, v212
v_exp_f32 v213, v213
v_exp_f32 v214, v214
v_exp_f32 v215, v215
v_exp_f32 v216, v216
v_exp_f32 v217, v217
v_exp_f32 v218, v218
v_exp_f32 v219, v219
v_pk_add_f32 v[224:225], v[212:213], v[214:215]
v_pk_add_f32 v[226:227], v[216:217], v[218:219]
v_pk_add_f32 v[224:225], v[224:225], v[226:227]
v_add_f32 v224, v224, v225
v_rcp_f32 v224, v224
s_mov_b32 s50, 0x05040100
s_mov_b32 s51, 0x07060302
v_pk_mul_f32 v[212:213], v[212:213], v[224:225] op_sel_hi:[1,0]
s_waitcnt lgkmcnt(0)
s_add_u32 m0, s44, 0
s_add_u32 s45, s55, 0
buffer_load_dwordx4 v234, s[8:11], s45 offen lds
v_pk_mul_f32 v[214:215], v[214:215], v[224:225] op_sel_hi:[1,0]
v_pk_mul_f32 v[216:217], v[216:217], v[224:225] op_sel_hi:[1,0]
v_pk_mul_f32 v[218:219], v[218:219], v[224:225] op_sel_hi:[1,0]
v_cvt_pk_bf16_f32 v220, v212, v213
v_cvt_pk_bf16_f32 v221, v214, v215
v_cvt_pk_bf16_f32 v222, v216, v217
v_cvt_pk_bf16_f32 v223, v218, v219
s_add_u32 m0, s44, 1024
s_add_u32 s45, s55, 10240
buffer_load_dwordx4 v235, s[8:11], s45 offen lds
v_perm_b32 v20, v128, v116, s50
v_perm_b32 v21, v128, v116, s51
v_perm_b32 v22, v129, v117, s50
v_perm_b32 v23, v129, v117, s51
v_perm_b32 v24, v130, v118, s50
v_perm_b32 v25, v130, v118, s51
v_perm_b32 v26, v131, v119, s50
s_add_u32 m0, s44, 2048
s_add_u32 s45, s55, 20480
buffer_load_dwordx4 v234, s[8:11], s45 offen lds
v_perm_b32 v27, v131, v119, s51
v_perm_b32 v28, v132, v120, s50
v_perm_b32 v29, v132, v120, s51
v_perm_b32 v30, v133, v121, s50
v_perm_b32 v31, v133, v121, s51
v_perm_b32 v32, v134, v122, s50
v_perm_b32 v33, v134, v122, s51
s_add_u32 m0, s44, 3072
s_add_u32 s45, s55, 30720
buffer_load_dwordx4 v235, s[8:11], s45 offen lds
v_perm_b32 v34, v135, v123, s50
v_perm_b32 v35, v135, v123, s51
v_perm_b32 v36, v136, v124, s50
v_perm_b32 v37, v136, v124, s51
v_perm_b32 v38, v137, v125, s50
v_perm_b32 v39, v137, v125, s51
v_dot2_f32_bf16 v40, v20, v220, 0
v_dot2_f32_bf16 v41, v21, v220, 0
v_dot2_f32_bf16 v42, v22, v220, 0
v_dot2_f32_bf16 v43, v23, v220, 0
v_dot2_f32_bf16 v44, v24, v220, 0
v_dot2_f32_bf16 v45, v25, v220, 0
v_dot2_f32_bf16 v46, v26, v220, 0
v_dot2_f32_bf16 v47, v27, v220, 0
v_dot2_f32_bf16 v48, v28, v220, 0
v_dot2_f32_bf16 v49, v29, v220, 0
v_dot2_f32_bf16 v50, v30, v220, 0
v_dot2_f32_bf16 v51, v31, v220, 0
v_dot2_f32_bf16 v52, v32, v220, 0
v_dot2_f32_bf16 v53, v33, v220, 0
v_dot2_f32_bf16 v54, v34, v220, 0
v_dot2_f32_bf16 v55, v35, v220, 0
v_dot2_f32_bf16 v56, v36, v220, 0
v_dot2_f32_bf16 v57, v37, v220, 0
v_dot2_f32_bf16 v58, v38, v220, 0
v_dot2_f32_bf16 v59, v39, v220, 0
v_perm_b32 v20, v152, v140, s50
v_perm_b32 v21, v152, v140, s51
v_perm_b32 v22, v153, v141, s50
v_perm_b32 v23, v153, v141, s51
v_perm_b32 v24, v154, v142, s50
v_perm_b32 v25, v154, v142, s51
v_perm_b32 v26, v155, v143, s50
v_perm_b32 v27, v155, v143, s51
v_perm_b32 v28, v156, v144, s50
v_perm_b32 v29, v156, v144, s51
v_perm_b32 v30, v157, v145, s50
v_perm_b32 v31, v157, v145, s51
v_perm_b32 v32, v158, v146, s50
v_perm_b32 v33, v158, v146, s51
v_perm_b32 v34, v159, v147, s50
v_perm_b32 v35, v159, v147, s51
v_perm_b32 v36, v160, v148, s50
v_perm_b32 v37, v160, v148, s51
v_perm_b32 v38, v161, v149, s50
v_perm_b32 v39, v161, v149, s51
v_dot2_f32_bf16 v40, v20, v221, v40
v_dot2_f32_bf16 v41, v21, v221, v41
v_dot2_f32_bf16 v42, v22, v221, v42
v_dot2_f32_bf16 v43, v23, v221, v43
v_dot2_f32_bf16 v44, v24, v221, v44
v_dot2_f32_bf16 v45, v25, v221, v45
v_dot2_f32_bf16 v46, v26, v221, v46
v_dot2_f32_bf16 v47, v27, v221, v47
v_dot2_f32_bf16 v48, v28, v221, v48
v_dot2_f32_bf16 v49, v29, v221, v49
v_dot2_f32_bf16 v50, v30, v221, v50
v_dot2_f32_bf16 v51, v31, v221, v51
v_dot2_f32_bf16 v52, v32, v221, v52
v_dot2_f32_bf16 v53, v33, v221, v53
v_dot2_f32_bf16 v54, v34, v221, v54
v_dot2_f32_bf16 v55, v35, v221, v55
v_dot2_f32_bf16 v56, v36, v221, v56
v_dot2_f32_bf16 v57, v37, v221, v57
v_dot2_f32_bf16 v58, v38, v221, v58
v_dot2_f32_bf16 v59, v39, v221, v59
v_perm_b32 v20, v176, v164, s50
v_perm_b32 v21, v176, v164, s51
v_perm_b32 v22, v177, v165, s50
v_perm_b32 v23, v177, v165, s51
v_perm_b32 v24, v178, v166, s50
v_perm_b32 v25, v178, v166, s51
v_perm_b32 v26, v179, v167, s50
v_perm_b32 v27, v179, v167, s51
v_perm_b32 v28, v180, v168, s50
v_perm_b32 v29, v180, v168, s51
v_perm_b32 v30, v181, v169, s50
v_perm_b32 v31, v181, v169, s51
v_perm_b32 v32, v182, v170, s50
v_perm_b32 v33, v182, v170, s51
v_perm_b32 v34, v183, v171, s50
v_perm_b32 v35, v183, v171, s51
v_perm_b32 v36, v184, v172, s50
v_perm_b32 v37, v184, v172, s51
v_perm_b32 v38, v185, v173, s50
v_perm_b32 v39, v185, v173, s51
v_dot2_f32_bf16 v40, v20, v222, v40
v_dot2_f32_bf16 v41, v21, v222, v41
v_dot2_f32_bf16 v42, v22, v222, v42
v_dot2_f32_bf16 v43, v23, v222, v43
v_dot2_f32_bf16 v44, v24, v222, v44
v_dot2_f32_bf16 v45, v25, v222, v45
v_dot2_f32_bf16 v46, v26, v222, v46
v_dot2_f32_bf16 v47, v27, v222, v47
v_dot2_f32_bf16 v48, v28, v222, v48
v_dot2_f32_bf16 v49, v29, v222, v49
v_dot2_f32_bf16 v50, v30, v222, v50
v_dot2_f32_bf16 v51, v31, v222, v51
v_dot2_f32_bf16 v52, v32, v222, v52
v_dot2_f32_bf16 v53, v33, v222, v53
v_dot2_f32_bf16 v54, v34, v222, v54
v_dot2_f32_bf16 v55, v35, v222, v55
v_dot2_f32_bf16 v56, v36, v222, v56
v_dot2_f32_bf16 v57, v37, v222, v57
v_dot2_f32_bf16 v58, v38, v222, v58
v_dot2_f32_bf16 v59, v39, v222, v59
v_perm_b32 v20, v200, v188, s50
v_perm_b32 v21, v200, v188, s51
v_perm_b32 v22, v201, v189, s50
v_perm_b32 v23, v201, v189, s51
v_perm_b32 v24, v202, v190, s50
v_perm_b32 v25, v202, v190, s51
v_perm_b32 v26, v203, v191, s50
v_perm_b32 v27, v203, v191, s51
v_perm_b32 v28, v204, v192, s50
v_perm_b32 v29, v204, v192, s51
v_perm_b32 v30, v205, v193, s50
v_perm_b32 v31, v205, v193, s51
v_perm_b32 v32, v206, v194, s50
v_perm_b32 v33, v206, v194, s51
v_perm_b32 v34, v207, v195, s50
v_perm_b32 v35, v207, v195, s51
v_perm_b32 v36, v208, v196, s50
v_perm_b32 v37, v208, v196, s51
v_perm_b32 v38, v209, v197, s50
v_perm_b32 v39, v209, v197, s51
v_dot2_f32_bf16 v40, v20, v223, v40
v_dot2_f32_bf16 v41, v21, v223, v41
v_dot2_f32_bf16 v42, v22, v223, v42
v_dot2_f32_bf16 v43, v23, v223, v43
v_dot2_f32_bf16 v44, v24, v223, v44
v_dot2_f32_bf16 v45, v25, v223, v45
v_dot2_f32_bf16 v46, v26, v223, v46
v_dot2_f32_bf16 v47, v27, v223, v47
v_dot2_f32_bf16 v48, v28, v223, v48
v_dot2_f32_bf16 v49, v29, v223, v49
v_dot2_f32_bf16 v50, v30, v223, v50
v_dot2_f32_bf16 v51, v31, v223, v51
v_dot2_f32_bf16 v52, v32, v223, v52
v_dot2_f32_bf16 v53, v33, v223, v53
v_dot2_f32_bf16 v54, v34, v223, v54
v_dot2_f32_bf16 v55, v35, v223, v55
v_dot2_f32_bf16 v56, v36, v223, v56
v_dot2_f32_bf16 v57, v37, v223, v57
v_dot2_f32_bf16 v58, v38, v223, v58
v_dot2_f32_bf16 v59, v39, v223, v59
v_cvt_pk_bf16_f32 v8, v40, v41
v_cvt_pk_bf16_f32 v9, v42, v43
v_cvt_pk_bf16_f32 v10, v44, v45
v_cvt_pk_bf16_f32 v11, v46, v47
v_cvt_pk_bf16_f32 v12, v48, v49
v_cvt_pk_bf16_f32 v13, v50, v51
v_cvt_pk_bf16_f32 v14, v52, v53
v_cvt_pk_bf16_f32 v15, v54, v55
v_cvt_pk_bf16_f32 v16, v56, v57
v_cvt_pk_bf16_f32 v17, v58, v59
buffer_store_dwordx4 v[8:11], v228, s[32:35], s52 offen
buffer_store_dwordx4 v[12:15], v228, s[32:35], s53 offen
buffer_store_dwordx2 v[16:17], v229, s[32:35], s54 offen
v_add_u32 v1, s57, v248
v_mov_b32 v4, 0x3f803f80
v_mov_b32 v5, 0x3f803f80
v_mov_b32 v6, 0x3f803f80
v_mov_b32 v7, 0x3f803f80
s_waitcnt vmcnt(12)
ds_read_b64_tr_b16 a[96:97], v1 offset:8192
ds_read_b64_tr_b16 a[98:99], v1 offset:8448
s_waitcnt vmcnt(11)
ds_read_b64_tr_b16 a[100:101], v1 offset:9216
ds_read_b64_tr_b16 a[102:103], v1 offset:9472
s_waitcnt vmcnt(10)
ds_read_b64_tr_b16 a[104:105], v1 offset:10240
ds_read_b64_tr_b16 a[106:107], v1 offset:10496
s_waitcnt vmcnt(9)
ds_read_b64_tr_b16 a[108:109], v1 offset:11264
ds_read_b64_tr_b16 a[110:111], v1 offset:11520
s_waitcnt vmcnt(8)
ds_read_b64_tr_b16 a[112:113], v1 offset:12288
ds_read_b64_tr_b16 a[114:115], v1 offset:12544
s_waitcnt lgkmcnt(8)
v_mfma_f32_32x32x16_bf16 a[224:239], a[96:99], v[4:7], a[224:239]
s_waitcnt vmcnt(7)
ds_read_b64_tr_b16 a[116:117], v1 offset:13312
ds_read_b64_tr_b16 a[118:119], v1 offset:13568
s_waitcnt lgkmcnt(8)
v_mfma_f32_32x32x16_bf16 a[224:239], a[100:103], v[4:7], a[224:239]
s_waitcnt lgkmcnt(6)
v_mfma_f32_32x32x16_bf16 a[224:239], a[104:107], v[4:7], a[224:239]
s_waitcnt lgkmcnt(4)
v_mfma_f32_32x32x16_bf16 a[224:239], a[108:111], v[4:7], a[224:239]
s_waitcnt lgkmcnt(2)
v_mfma_f32_32x32x16_bf16 a[224:239], a[112:115], v[4:7], a[224:239]
s_waitcnt lgkmcnt(0)
v_mfma_f32_32x32x16_bf16 a[224:239], a[116:119], v[4:7], a[224:239]
s_waitcnt vmcnt(0) lgkmcnt(0)
s_barrier
s_cmp_lg_u32 s6, 0
s_cbranch_scc1 Lb_30
s_lshl_b32 s3, s5, 2
s_add_u32 s3, s3, 1736960
v_mov_b32 v255, s7
v_mov_b32 v254, 0
s_mov_b64 exec, 1
s_cmp_eq_u32 s90, 0
s_cbranch_scc1 Lb_31
buffer_store_dword v255, v254, s[32:35], s3 offen
s_mov_b64 exec, -1
s_branch Lb_30
Lb_31:
buffer_wbl2 sc1
s_waitcnt vmcnt(0)
buffer_store_dword v255, v254, s[32:35], s3 offen sc0 sc1
s_mov_b64 exec, -1
Lb_30:
s_lshl_b32 s58, s6, 13
s_add_u32 s58, s58, 122880
s_cmp_ge_u32 s5, 20
s_cbranch_scc1 Lpf0
s_cmp_lg_u32 s6, 0
s_cbranch_scc1 Lq_32
s_mov_b32 s3, 1736960
v_lshlrev_b32 v254, 2, v0
s_mov_b32 exec_hi, 0
buffer_load_dword v255, v254, s[32:35], s3 offen sc1
s_mov_b64 exec, -1
Lq_32:
v_mov_b32 v224, v249
v_xor_b32 v225, 64, v249
v_add_u32 v226, 40960, v224
v_add_u32 v227, 40960, v225
v_and_b32 v232, 31, v0
v_lshrrev_b32 v233, 5, v0
v_lshlrev_b32 v229, 3, v232
v_lshlrev_b32 v232, 4, v232
v_mul_u32_u24 v233, 4352, v233
v_add_u32 v228, v233, v232
s_lshl_b32 s40, s98, 2
s_add_u32 s40, s40, s6
s_lshl_b32 s41, s40, 9
s_add_u32 s42, s41, 256
s_mul_i32 s43, s97, 34816
s_add_u32 s43, s43, s41
s_add_u32 s43, s43, 348416
s_lshl_b32 s44, s97, 11
s_lshl_b32 s45, s40, 8
s_add_u32 s44, s44, s45
s_add_u32 s44, s44, 1712128
s_mov_b32 s50, 0x3f803f80
s_lshl_b32 s92, s98, 4
s_lshl_b32 s92, 0xfffff, s92
v_lshrrev_b32 v233, 5, v0
v_bfe_u32 v234, v0, 1, 3
v_xor_b32 v233, v233, v234
v_lshlrev_b32 v233, 4, v233
v_lshl_add_u32 v232, v232, 3, v233
v_add_u32 v232, s57, v232
v_xor_b32 v233, 32, v232
v_xor_b32 v234, 64, v232
v_xor_b32 v235, 96, v232
ds_read_b128 v[184:187], v232
ds_read_b128 v[188:191], v233
ds_read_b128 v[192:195], v234
ds_read_b128 v[196:199], v235
ds_read_b64_tr_b16 v[200:201], v224 offset:0
ds_read_b64_tr_b16 v[202:203], v224 offset:512
ds_read_b64_tr_b16 v[204:205], v225 offset:0
ds_read_b64_tr_b16 v[206:207], v225 offset:512
ds_read_b64_tr_b16 v[208:209], v224 offset:2048
ds_read_b64_tr_b16 v[210:211], v224 offset:2560
ds_read_b64_tr_b16 v[212:213], v225 offset:2048
ds_read_b64_tr_b16 v[214:215], v225 offset:2560
s_waitcnt lgkmcnt(11)
v_lshlrev_b32 v8, 16, v184
v_and_b32 v9, 0xffff0000, v184
v_lshlrev_b32 v10, 16, v185
v_and_b32 v11, 0xffff0000, v185
v_lshlrev_b32 v12, 16, v186
v_and_b32 v13, 0xffff0000, v186
v_lshlrev_b32 v14, 16, v187
v_and_b32 v15, 0xffff0000, v187
s_waitcnt lgkmcnt(10)
v_lshlrev_b32 v16, 16, v188
v_and_b32 v17, 0xffff0000, v188
v_lshlrev_b32 v18, 16, v189
v_and_b32 v19, 0xffff0000, v189
v_lshlrev_b32 v20, 16, v190
v_and_b32 v21, 0xffff0000, v190
v_lshlrev_b32 v22, 16, v191
v_and_b32 v23, 0xffff0000, v191
s_waitcnt lgkmcnt(9)
v_lshlrev_b32 v24, 16, v192
v_and_b32 v25, 0xffff0000, v192
v_lshlrev_b32 v26, 16, v193
v_and_b32 v27, 0xffff0000, v193
v_lshlrev_b32 v28, 16, v194
v_and_b32 v29, 0xffff0000, v194
v_lshlrev_b32 v30, 16, v195
v_and_b32 v31, 0xffff0000, v195
s_waitcnt lgkmcnt(8)
v_lshlrev_b32 v32, 16, v196
v_and_b32 v33, 0xffff0000, v196
v_lshlrev_b32 v34, 16, v197
v_and_b32 v35, 0xffff0000, v197
v_lshlrev_b32 v36, 16, v198
v_and_b32 v37, 0xffff0000, v198
v_lshlrev_b32 v38, 16, v199
v_and_b32 v39, 0xffff0000, v199
s_cmp_lg_u32 s6, 0
s_cbranch_scc1 La_33
s_mov_b32 s3, 1736960
s_mov_b32 exec_lo, s92
s_mov_b32 exec_hi, 0
s_branch Lac_35
Lap_34:
s_sub_u32 s91, s91, 1
s_cbranch_scc1 Lend
s_waitcnt vmcnt(0)
buffer_load_dword v255, v254, s[32:35], s3 offen sc1
Lac_35:
s_waitcnt vmcnt(0)
s_waitcnt vmcnt(0)
v_cmp_ne_u32 vcc, s7, v255
s_cbranch_vccnz Lap_34
s_mov_b64 exec, -1
s_cmp_lg_u32 s90, 0
s_cbranch_scc1 La_33
buffer_inv sc1
s_waitcnt vmcnt(0)
La_33:
s_add_u32 m0, s57, 0
s_add_u32 s101, s96, 0
buffer_load_dwordx4 v244, s[24:27], s101 offen offset:0  lds
buffer_load_dwordx4 v245, s[24:27], s101 offen offset:1024  lds
buffer_load_dwordx4 v246, s[24:27], s101 offen offset:2048  lds
buffer_load_dwordx4 v247, s[24:27], s101 offen offset:3072  lds
s_add_u32 m0, s57, 8192
s_add_u32 s101, s96, 40960
buffer_load_dwordx4 v244, s[24:27], s101 offen offset:0  lds
buffer_load_dwordx4 v245, s[24:27], s101 offen offset:1024  lds
buffer_load_dwordx4 v246, s[24:27], s101 offen offset:2048  lds
buffer_load_dwordx4 v247, s[24:27], s101 offen offset:3072  lds
s_add_u32 m0, s57, 12288
s_add_u32 s101, s96, 81920
buffer_load_dwordx4 v244, s[24:27], s101 offen offset:0  lds
buffer_load_dwordx4 v245, s[24:27], s101 offen offset:1024  lds
s_waitcnt lgkmcnt(0)
s_barrier
s_add_u32 s46, s42, 0
buffer_load_dwordx4 v[40:43], v228, s[32:35], s46 offen sc1
s_add_u32 s46, s42, 8704
buffer_load_dwordx4 v[44:47], v228, s[32:35], s46 offen sc1
s_add_u32 s46, s42, 17408
buffer_load_dwordx4 v[48:51], v228, s[32:35], s46 offen sc1
s_add_u32 s46, s42, 26112
buffer_load_dwordx4 v[52:55], v228, s[32:35], s46 offen sc1
s_add_u32 s46, s42, 34816
buffer_load_dwordx4 v[56:59], v228, s[32:35], s46 offen sc1
s_add_u32 s46, s42, 43520
buffer_load_dwordx4 v[60:63], v228, s[32:35], s46 offen sc1
s_add_u32 s46, s42, 52224
buffer_load_dwordx4 v[64:67], v228, s[32:35], s46 offen sc1
s_add_u32 s46, s42, 60928
buffer_load_dwordx4 v[68:71], v228, s[32:35], s46 offen sc1
s_add_u32 s46, s42, 69632
buffer_load_dwordx4 v[72:75], v228, s[32:35], s46 offen sc1
s_add_u32 s46, s42, 78336
buffer_load_dwordx4 v[76:79], v228, s[32:35], s46 offen sc1
s_add_u32 s46, s42, 87040
buffer_load_dwordx4 v[80:83], v228, s[32:35], s46 offen sc1
s_add_u32 s46, s42, 95744
buffer_load_dwordx4 v[84:87], v228, s[32:35], s46 offen sc1
s_waitcnt vmcnt(11)
v_mfma_f32_32x32x16_bf16 v[8:23], v[200:203], v[40:43], v[8:23]
ds_read_b64_tr_b16 v[216:217], v224 offset:4096
ds_read_b64_tr_b16 v[218:219], v224 offset:4608
s_add_u32 s46, s42, 104448
buffer_load_dwordx4 v[88:91], v228, s[32:35], s46 offen sc1
v_mfma_f32_32x32x16_bf16 v[24:39], v[204:207], v[40:43], v[24:39]
ds_read_b64_tr_b16 v[220:221], v225 offset:4096
ds_read_b64_tr_b16 v[222:223], v225 offset:4608
s_waitcnt vmcnt(11)
v_mfma_f32_32x32x16_bf16 v[8:23], v[208:211], v[44:47], v[8:23]
ds_read_b64_tr_b16 v[200:201], v224 offset:6144
ds_read_b64_tr_b16 v[202:203], v224 offset:6656
s_add_u32 s46, s42, 113152
buffer_load_dwordx4 v[92:95], v228, s[32:35], s46 offen sc1
v_mfma_f32_32x32x16_bf16 v[24:39], v[212:215], v[44:47], v[24:39]
ds_read_b64_tr_b16 v[204:205], v225 offset:6144
ds_read_b64_tr_b16 v[206:207], v225 offset:6656
s_waitcnt vmcnt(11) lgkmcnt(6)
v_mfma_f32_32x32x16_bf16 v[8:23], v[216:219], v[48:51], v[8:23]
ds_read_b64_tr_b16 v[208:209], v224 offset:8192
ds_read_b64_tr_b16 v[210:211], v224 offset:8704
s_add_u32 s46, s42, 121856
buffer_load_dwordx4 v[96:99], v228, s[32:35], s46 offen sc1
s_waitcnt lgkmcnt(6)
v_mfma_f32_32x32x16_bf16 v[24:39], v[220:223], v[48:51], v[24:39]
ds_read_b64_tr_b16 v[212:213], v225 offset:8192
ds_read_b64_tr_b16 v[214:215], v225 offset:8704
s_waitcnt vmcnt(11) lgkmcnt(6)
v_mfma_f32_32x32x16_bf16 v[8:23], v[200:203], v[52:55], v[8:23]
ds_read_b64_tr_b16 v[216:217], v224 offset:10240
ds_read_b64_tr_b16 v[218:219], v224 offset:10752
s_add_u32 s46, s42, 130560
buffer_load_dwordx4 v[100:103], v228, s[32:35], s46 offen sc1
s_waitcnt lgkmcnt(6)
v_mfma_f32_32x32x16_bf16 v[24:39], v[204:207], v[52:55], v[24:39]
ds_read_b64_tr_b16 v[220:221], v225 offset:10240
ds_read_b64_tr_b16 v[222:223], v225 offset:10752
s_waitcnt vmcnt(11) lgkmcnt(6)
v_mfma_f32_32x32x16_bf16 v[8:23], v[208:211], v[56:59], v[8:23]
ds_read_b64_tr_b16 v[200:201], v224 offset:12288
ds_read_b64_tr_b16 v[202:203], v224 offset:12800
s_add_u32 s46, s42, 139264
buffer_load_dwordx4 v[104:107], v228, s[32:35], s46 offen sc1
s_waitcnt lgkmcnt(6)
v_mfma_f32_32x32x16_bf16 v[24:39], v[212:215], v[56:59], v[24:39]
ds_read_b64_tr_b16 v[204:205], v225 offset:12288
ds_read_b64_tr_b16 v[206:207], v225 offset:12800
s_waitcnt vmcnt(11) lgkmcnt(6)
v_mfma_f32_32x32x16_bf16 v[8:23], v[216:219], v[60:63], v[8:23]
ds_read_b64_tr_b16 v[208:209], v224 offset:14336
ds_read_b64_tr_b16 v[210:211], v224 offset:14848
s_add_u32 s46, s42, 147968
buffer_load_dwordx4 v[108:111], v228, s[32:35], s46 offen sc1
s_waitcnt lgkmcnt(6)
v_mfma_f32_32x32x16_bf16 v[24:39], v[220:223], v[60:63], v[24:39]
ds_read_b64_tr_b16 v[212:213], v225 offset:14336
ds_read_b64_tr_b16 v[214:215], v225 offset:14848
s_waitcnt vmcnt(11) lgkmcnt(6)
v_mfma_f32_32x32x16_bf16 v[8:23], v[200:203], v[64:67], v[8:23]
ds_read_b64_tr_b16 v[216:217], v224 offset:16384
ds_read_b64_tr_b16 v[218:219], v224 offset:16896
s_add_u32 s46, s42, 156672
buffer_load_dwordx4 v[112:115], v228, s[32:35], s46 offen sc1
s_waitcnt lgkmcnt(6)
v_mfma_f32_32x32x16_bf16 v[24:39], v[204:207], v[64:67], v[24:39]
ds_read_b64_tr_b16 v[220:221], v225 offset:16384
ds_read_b64_tr_b16 v[222:223], v225 offset:16896
s_waitcnt vmcnt(11) lgkmcnt(6)
v_mfma_f32_32x32x16_bf16 v[8:23], v[208:211], v[68:71], v[8:23]
ds_read_b64_tr_b16 v[200:201], v224 offset:18432
ds_read_b64_tr_b16 v[202:203], v224 offset:18944
s_add_u32 s46, s42, 165376
buffer_load_dwordx4 v[116:119], v228, s[32:35], s46 offen sc1
s_waitcnt lgkmcnt(6)
v_mfma_f32_32x32x16_bf16 v[24:39], v[212:215], v[68:71], v[24:39]
ds_read_b64_tr_b16 v[204:205], v225 offset:18432
ds_read_b64_tr_b16 v[206:207], v225 offset:18944
s_waitcnt vmcnt(11) lgkmcnt(6)
v_mfma_f32_32x32x16_bf16 v[8:23], v[216:219], v[72:75], v[8:23]
ds_read_b64_tr_b16 v[208:209], v224 offset:20480
ds_read_b64_tr_b16 v[210:211], v224 offset:20992
s_add_u32 s46, s42, 174080
buffer_load_dwordx4 v[120:123], v228, s[32:35], s46 offen sc1
s_waitcnt lgkmcnt(6)
v_mfma_f32_32x32x16_bf16 v[24:39], v[220:223], v[72:75], v[24:39]
ds_read_b64_tr_b16 v[212:213], v225 offset:20480
ds_read_b64_tr_b16 v[214:215], v225 offset:20992
s_waitcnt vmcnt(11) lgkmcnt(6)
v_mfma_f32_32x32x16_bf16 v[8:23], v[200:203], v[76:79], v[8:23]
ds_read_b64_tr_b16 v[216:217], v224 offset:22528
ds_read_b64_tr_b16 v[218:219], v224 offset:23040
s_add_u32 s46, s42, 182784
buffer_load_dwordx4 v[124:127], v228, s[32:35], s46 offen sc1
s_waitcnt lgkmcnt(6)
v_mfma_f32_32x32x16_bf16 v[24:39], v[204:207], v[76:79], v[24:39]
ds_read_b64_tr_b16 v[220:221], v225 offset:22528
ds_read_b64_tr_b16 v[222:223], v225 offset:23040
s_waitcnt vmcnt(11) lgkmcnt(6)
v_mfma_f32_32x32x16_bf16 v[8:23], v[208:211], v[80:83], v[8:23]
ds_read_b64_tr_b16 v[200:201], v224 offset:24576
ds_read_b64_tr_b16 v[202:203], v224 offset:25088
s_add_u32 s46, s42, 191488
buffer_load_dwordx4 v[128:131], v228, s[32:35], s46 offen sc1
s_waitcnt lgkmcnt(6)
v_mfma_f32_32x32x16_bf16 v[24:39], v[212:215], v[80:83], v[24:39]
ds_read_b64_tr_b16 v[204:205], v225 offset:24576
ds_read_b64_tr_b16 v[206:207], v225 offset:25088
s_waitcnt vmcnt(11) lgkmcnt(6)
v_mfma_f32_32x32x16_bf16 v[8:23], v[216:219], v[84:87], v[8:23]
ds_read_b64_tr_b16 v[208:209], v224 offset:26624
ds_read_b64_tr_b16 v[210:211], v224 offset:27136
s_add_u32 s46, s42, 200192
buffer_load_dwordx4 v[132:135], v228, s[32:35], s46 offen sc1
s_waitcnt lgkmcnt(6)
v_mfma_f32_32x32x16_bf16 v[24:39], v[220:223], v[84:87], v[24:39]
ds_read_b64_tr_b16 v[212:213], v225 offset:26624
ds_read_b64_tr_b16 v[214:215], v225 offset:27136
s_waitcnt vmcnt(11) lgkmcnt(6)
v_mfma_f32_32x32x16_bf16 v[8:23], v[200:203], v[88:91], v[8:23]
ds_read_b64_tr_b16 v[216:217], v224 offset:28672
ds_read_b64_tr_b16 v[218:219], v224 offset:29184
s_add_u32 s46, s42, 208896
buffer_load_dwordx4 v[136:139], v228, s[32:35], s46 offen sc1
s_waitcnt lgkmcnt(6)
v_mfma_f32_32x32x16_bf16 v[24:39], v[204:207], v[88:91], v[24:39]
ds_read_b64_tr_b16 v[220:221], v225 offset:28672
ds_read_b64_tr_b16 v[222:223], v225 offset:29184
s_waitcnt vmcnt(11) lgkmcnt(6)
v_mfma_f32_32x32x16_bf16 v[8:23], v[208:211], v[92:95], v[8:23]
ds_read_b64_tr_b16 v[200:201], v224 offset:30720
ds_read_b64_tr_b16 v[202:203], v224 offset:31232
s_add_u32 s46, s42, 217600
buffer_load_dwordx4 v[140:143], v228, s[32:35], s46 offen sc1
s_waitcnt lgkmcnt(6)
v_mfma_f32_32x32x16_bf16 v[24:39], v[212:215], v[92:95], v[24:39]
ds_read_b64_tr_b16 v[204:205], v225 offset:30720
ds_read_b64_tr_b16 v[206:207], v225 offset:31232
s_waitcnt vmcnt(11) lgkmcnt(6)
v_mfma_f32_32x32x16_bf16 v[8:23], v[216:219], v[96:99], v[8:23]
ds_read_b64_tr_b16 v[208:209], v224 offset:32768
ds_read_b64_tr_b16 v[210:211], v224 offset:33280
s_add_u32 s46, s42, 226304
buffer_load_dwordx4 v[144:147], v228, s[32:35], s46 offen sc1
s_waitcnt lgkmcnt(6)
v_mfma_f32_32x32x16_bf16 v[24:39], v[220:223], v[96:99], v[24:39]
ds_read_b64_tr_b16 v[212:213], v225 offset:32768
ds_read_b64_tr_b16 v[214:215], v225 offset:33280
s_waitcnt vmcnt(11) lgkmcnt(6)
v_mfma_f32_32x32x16_bf16 v[8:23], v[200:203], v[100:103], v[8:23]
ds_read_b64_tr_b16 v[216:217], v224 offset:34816
ds_read_b64_tr_b16 v[218:219], v224 offset:35328
s_add_u32 s46, s42, 235008
buffer_load_dwordx4 v[148:151], v228, s[32:35], s46 offen sc1
s_waitcnt lgkmcnt(6)
v_mfma_f32_32x32x16_bf16 v[24:39], v[204:207], v[100:103], v[24:39]
ds_read_b64_tr_b16 v[220:221], v225 offset:34816
ds_read_b64_tr_b16 v[222:223], v225 offset:35328
s_waitcnt vmcnt(11) lgkmcnt(6)
v_mfma_f32_32x32x16_bf16 v[8:23], v[208:211], v[104:107], v[8:23]
ds_read_b64_tr_b16 v[200:201], v224 offset:36864
ds_read_b64_tr_b16 v[202:203], v224 offset:37376
s_add_u32 s46, s42, 243712
buffer_load_dwordx4 v[152:155], v228, s[32:35], s46 offen sc1
s_waitcnt lgkmcnt(6)
v_mfma_f32_32x32x16_bf16 v[24:39], v[212:215], v[104:107], v[24:39]
ds_read_b64_tr_b16 v[204:205], v225 offset:36864
ds_read_b64_tr_b16 v[206:207], v225 offset:37376
s_waitcnt vmcnt(11) lgkmcnt(6)
v_mfma_f32_32x32x16_bf16 v[8:23], v[216:219], v[108:111], v[8:23]
ds_read_b64_tr_b16 v[208:209], v224 offset:38912
ds_read_b64_tr_b16 v[210:211], v224 offset:39424
s_add_u32 s46, s42, 252416
buffer_load_dwordx4 v[156:159], v228, s[32:35], s46 offen sc1
s_waitcnt lgkmcnt(6)
v_mfma_f32_32x32x16_bf16 v[24:39], v[220:223], v[108:111], v[24:39]
ds_read_b64_tr_b16 v[212:213], v225 offset:38912
ds_read_b64_tr_b16 v[214:215], v225 offset:39424
s_waitcnt vmcnt(11) lgkmcnt(6)
v_mfma_f32_32x32x16_bf16 v[8:23], v[200:203], v[112:115], v[8:23]
ds_read_b64_tr_b16 v[216:217], v226 offset:0
ds_read_b64_tr_b16 v[218:219], v226 offset:512
s_add_u32 s46, s42, 261120
buffer_load_dwordx4 v[160:163], v228, s[32:35], s46 offen sc1
s_waitcnt lgkmcnt(6)
v_mfma_f32_32x32x16_bf16 v[24:39], v[204:207], v[112:115], v[24:39]
ds_read_b64_tr_b16 v[220:221], v227 offset:0
ds_read_b64_tr_b16 v[222:223], v227 offset:512
s_waitcnt vmcnt(11) lgkmcnt(6)
v_mfma_f32_32x32x16_bf16 v[8:23], v[208:211], v[116:119], v[8:23]
ds_read_b64_tr_b16 v[200:201], v226 offset:2048
ds_read_b64_tr_b16 v[202:203], v226 offset:2560
s_add_u32 s46, s42, 269824
buffer_load_dwordx4 v[164:167], v228, s[32:35], s46 offen sc1
s_waitcnt lgkmcnt(6)
v_mfma_f32_32x32x16_bf16 v[24:39], v[212:215], v[116:119], v[24:39]
ds_read_b64_tr_b16 v[204:205], v227 offset:2048
ds_read_b64_tr_b16 v[206:207], v227 offset:2560
s_waitcnt vmcnt(11) lgkmcnt(6)
v_mfma_f32_32x32x16_bf16 v[8:23], v[216:219], v[120:123], v[8:23]
ds_read_b64_tr_b16 v[208:209], v226 offset:4096
ds_read_b64_tr_b16 v[210:211], v226 offset:4608
s_add_u32 s46, s42, 278528
buffer_load_dwordx4 v[168:171], v228, s[32:35], s46 offen sc1
s_waitcnt lgkmcnt(6)
v_mfma_f32_32x32x16_bf16 v[24:39], v[220:223], v[120:123], v[24:39]
ds_read_b64_tr_b16 v[212:213], v227 offset:4096
ds_read_b64_tr_b16 v[214:215], v227 offset:4608
s_waitcnt vmcnt(11) lgkmcnt(6)
v_mfma_f32_32x32x16_bf16 v[8:23], v[200:203], v[124:127], v[8:23]
ds_read_b64_tr_b16 v[216:217], v226 offset:6144
ds_read_b64_tr_b16 v[218:219], v226 offset:6656
s_add_u32 s46, s42, 287232
buffer_load_dwordx4 v[172:175], v228, s[32:35], s46 offen sc1
s_waitcnt lgkmcnt(6)
v_mfma_f32_32x32x16_bf16 v[24:39], v[204:207], v[124:127], v[24:39]
ds_read_b64_tr_b16 v[220:221], v227 offset:6144
ds_read_b64_tr_b16 v[222:223], v227 offset:6656
s_waitcnt vmcnt(11) lgkmcnt(6)
v_mfma_f32_32x32x16_bf16 v[8:23], v[208:211], v[128:131], v[8:23]
ds_read_b64_tr_b16 v[200:201], v226 offset:8192
ds_read_b64_tr_b16 v[202:203], v226 offset:8704
s_add_u32 s46, s42, 295936
buffer_load_dwordx4 v[176:179], v228, s[32:35], s46 offen sc1
s_waitcnt lgkmcnt(6)
v_mfma_f32_32x32x16_bf16 v[24:39], v[212:215], v[128:131], v[24:39]
ds_read_b64_tr_b16 v[204:205], v227 offset:8192
ds_read_b64_tr_b16 v[206:207], v227 offset:8704
s_waitcnt vmcnt(11) lgkmcnt(6)
v_mfma_f32_32x32x16_bf16 v[8:23], v[216:219], v[132:135], v[8:23]
ds_read_b64_tr_b16 v[208:209], v226 offset:10240
ds_read_b64_tr_b16 v[210:211], v226 offset:10752
s_add_u32 s46, s42, 304640
buffer_load_dwordx4 v[180:183], v228, s[32:35], s46 offen sc1
s_waitcnt lgkmcnt(6)
v_mfma_f32_32x32x16_bf16 v[24:39], v[220:223], v[132:135], v[24:39]
ds_read_b64_tr_b16 v[212:213], v227 offset:10240
ds_read_b64_tr_b16 v[214:215], v227 offset:10752
s_waitcnt vmcnt(11) lgkmcnt(6)
v_mfma_f32_32x32x16_bf16 v[8:23], v[200:203], v[136:139], v[8:23]
ds_read_b64_tr_b16 v[216:217], v226 offset:12288
ds_read_b64_tr_b16 v[218:219], v226 offset:12800
s_add_u32 s46, s42, 313344
buffer_load_dwordx4 v[184:187], v228, s[32:35], s46 offen sc1
s_waitcnt lgkmcnt(6)
v_mfma_f32_32x32x16_bf16 v[24:39], v[204:207], v[136:139], v[24:39]
ds_read_b64_tr_b16 v[220:221], v227 offset:12288
ds_read_b64_tr_b16 v[222:223], v227 offset:12800
s_waitcnt vmcnt(11) lgkmcnt(6)
v_mfma_f32_32x32x16_bf16 v[8:23], v[208:211], v[140:143], v[8:23]
ds_read_b64_tr_b16 v[200:201], v226 offset:14336
ds_read_b64_tr_b16 v[202:203], v226 offset:14848
s_add_u32 s46, s42, 322048
buffer_load_dwordx4 v[188:191], v228, s[32:35], s46 offen sc1
s_waitcnt lgkmcnt(6)
v_mfma_f32_32x32x16_bf16 v[24:39], v[212:215], v[140:143], v[24:39]
ds_read_b64_tr_b16 v[204:205], v227 offset:14336
ds_read_b64_tr_b16 v[206:207], v227 offset:14848
s_waitcnt vmcnt(11) lgkmcnt(6)
v_mfma_f32_32x32x16_bf16 v[8:23], v[216:219], v[144:147], v[8:23]
ds_read_b64_tr_b16 v[208:209], v226 offset:16384
ds_read_b64_tr_b16 v[210:211], v226 offset:16896
s_add_u32 s46, s42, 330752
buffer_load_dwordx4 v[192:195], v228, s[32:35], s46 offen sc1
s_waitcnt lgkmcnt(6)
v_mfma_f32_32x32x16_bf16 v[24:39], v[220:223], v[144:147], v[24:39]
ds_read_b64_tr_b16 v[212:213], v227 offset:16384
ds_read_b64_tr_b16 v[214:215], v227 offset:16896
s_waitcnt vmcnt(11) lgkmcnt(6)
v_mfma_f32_32x32x16_bf16 v[8:23], v[200:203], v[148:151], v[8:23]
ds_read_b64_tr_b16 v[216:217], v226 offset:18432
ds_read_b64_tr_b16 v[218:219], v226 offset:18944
s_add_u32 s46, s42, 339456
buffer_load_dwordx4 v[196:199], v228, s[32:35], s46 offen sc1
s_waitcnt lgkmcnt(6)
v_mfma_f32_32x32x16_bf16 v[24:39], v[204:207], v[148:151], v[24:39]
ds_read_b64_tr_b16 v[220:221], v227 offset:18432
ds_read_b64_tr_b16 v[222:223], v227 offset:18944
s_waitcnt vmcnt(11) lgkmcnt(6)
v_mfma_f32_32x32x16_bf16 v[8:23], v[208:211], v[152:155], v[8:23]
ds_read_b64_tr_b16 v[200:201], v226 offset:20480
ds_read_b64_tr_b16 v[202:203], v226 offset:20992
s_add_u32 m0, s57, 4096
s_add_u32 s101, s94, 1658880
buffer_load_dwordx4 v240, s[20:23], s101 offen offset:0  lds
s_waitcnt lgkmcnt(6)
v_mfma_f32_32x32x16_bf16 v[24:39], v[212:215], v[152:155], v[24:39]
ds_read_b64_tr_b16 v[204:205], v227 offset:20480
ds_read_b64_tr_b16 v[206:207], v227 offset:20992
buffer_load_dwordx4 v241, s[20:23], s101 offen offset:1024  lds
s_waitcnt vmcnt(12) lgkmcnt(6)
v_mfma_f32_32x32x16_bf16 v[8:23], v[216:219], v[156:159], v[8:23]
ds_read_b64_tr_b16 v[208:209], v226 offset:22528
ds_read_b64_tr_b16 v[210:211], v226 offset:23040
buffer_load_dwordx4 v242, s[20:23], s101 offen offset:2048  lds
s_waitcnt lgkmcnt(6)
v_mfma_f32_32x32x16_bf16 v[24:39], v[220:223], v[156:159], v[24:39]
ds_read_b64_tr_b16 v[212:213], v227 offset:22528
ds_read_b64_tr_b16 v[214:215], v227 offset:23040
buffer_load_dwordx4 v243, s[20:23], s101 offen offset:3072  lds
s_waitcnt vmcnt(13) lgkmcnt(6)
v_mfma_f32_32x32x16_bf16 v[8:23], v[200:203], v[160:163], v[8:23]
ds_read_b64_tr_b16 v[216:217], v226 offset:24576
ds_read_b64_tr_b16 v[218:219], v226 offset:25088
s_add_u32 m0, s57, 14336
s_add_u32 s101, s94, 1880064
buffer_load_dwordx4 v240, s[20:23], s101 offen offset:0  lds
s_waitcnt lgkmcnt(6)
v_mfma_f32_32x32x16_bf16 v[24:39], v[204:207], v[160:163], v[24:39]
ds_read_b64_tr_b16 v[220:221], v227 offset:24576
ds_read_b64_tr_b16 v[222:223], v227 offset:25088
buffer_load_dwordx4 v241, s[20:23], s101 offen offset:1024  lds
s_waitcnt vmcnt(14) lgkmcnt(6)
v_mfma_f32_32x32x16_bf16 v[8:23], v[208:211], v[164:167], v[8:23]
ds_read_b64_tr_b16 v[200:201], v226 offset:26624
ds_read_b64_tr_b16 v[202:203], v226 offset:27136
buffer_load_dwordx4 v242, s[20:23], s101 offen offset:2048  lds
s_waitcnt lgkmcnt(6)
v_mfma_f32_32x32x16_bf16 v[24:39], v[212:215], v[164:167], v[24:39]
ds_read_b64_tr_b16 v[204:205], v227 offset:26624
ds_read_b64_tr_b16 v[206:207], v227 offset:27136
buffer_load_dwordx4 v243, s[20:23], s101 offen offset:3072  lds
s_waitcnt vmcnt(15) lgkmcnt(6)
v_mfma_f32_32x32x16_bf16 v[8:23], v[216:219], v[168:171], v[8:23]
ds_read_b64_tr_b16 v[208:209], v226 offset:28672
ds_read_b64_tr_b16 v[210:211], v226 offset:29184
s_add_u32 m0, s57, 18432
s_add_u32 s101, s94, 2101248
buffer_load_dwordx4 v240, s[20:23], s101 offen offset:0  lds
s_waitcnt lgkmcnt(6)
v_mfma_f32_32x32x16_bf16 v[24:39], v[220:223], v[168:171], v[24:39]
ds_read_b64_tr_b16 v[212:213], v227 offset:28672
ds_read_b64_tr_b16 v[214:215], v227 offset:29184
buffer_load_dwordx4 v241, s[20:23], s101 offen offset:1024  lds
s_waitcnt vmcnt(16) lgkmcnt(6)
v_mfma_f32_32x32x16_bf16 v[8:23], v[200:203], v[172:175], v[8:23]
ds_read_b64_tr_b16 v[216:217], v226 offset:30720
ds_read_b64_tr_b16 v[218:219], v226 offset:31232
s_waitcnt lgkmcnt(6)
v_mfma_f32_32x32x16_bf16 v[24:39], v[204:207], v[172:175], v[24:39]
ds_read_b64_tr_b16 v[220:221], v227 offset:30720
ds_read_b64_tr_b16 v[222:223], v227 offset:31232
s_waitcnt vmcnt(15) lgkmcnt(6)
v_mfma_f32_32x32x16_bf16 v[8:23], v[208:211], v[176:179], v[8:23]
ds_read_b64_tr_b16 v[200:201], v226 offset:32768
ds_read_b64_tr_b16 v[202:203], v226 offset:33280
s_waitcnt lgkmcnt(6)
v_mfma_f32_32x32x16_bf16 v[24:39], v[212:215], v[176:179], v[24:39]
ds_read_b64_tr_b16 v[204:205], v227 offset:32768
ds_read_b64_tr_b16 v[206:207], v227 offset:33280
s_waitcnt vmcnt(14) lgkmcnt(6)
v_mfma_f32_32x32x16_bf16 v[8:23], v[216:219], v[180:183], v[8:23]
ds_read_b64_tr_b16 v[208:209], v226 offset:34816
ds_read_b64_tr_b16 v[210:211], v226 offset:35328
s_waitcnt lgkmcnt(6)
v_mfma_f32_32x32x16_bf16 v[24:39], v[220:223], v[180:183], v[24:39]
ds_read_b64_tr_b16 v[212:213], v227 offset:34816
ds_read_b64_tr_b16 v[214:215], v227 offset:35328
s_waitcnt vmcnt(13) lgkmcnt(6)
v_mfma_f32_32x32x16_bf16 v[8:23], v[200:203], v[184:187], v[8:23]
ds_read_b64_tr_b16 v[216:217], v226 offset:36864
ds_read_b64_tr_b16 v[218:219], v226 offset:37376
s_waitcnt lgkmcnt(6)
v_mfma_f32_32x32x16_bf16 v[24:39], v[204:207], v[184:187], v[24:39]
ds_read_b64_tr_b16 v[220:221], v227 offset:36864
ds_read_b64_tr_b16 v[222:223], v227 offset:37376
s_waitcnt vmcnt(12) lgkmcnt(6)
v_mfma_f32_32x32x16_bf16 v[8:23], v[208:211], v[188:191], v[8:23]
ds_read_b64_tr_b16 v[200:201], v226 offset:38912
ds_read_b64_tr_b16 v[202:203], v226 offset:39424
s_waitcnt lgkmcnt(6)
v_mfma_f32_32x32x16_bf16 v[24:39], v[212:215], v[188:191], v[24:39]
ds_read_b64_tr_b16 v[204:205], v227 offset:38912
ds_read_b64_tr_b16 v[206:207], v227 offset:39424
s_waitcnt vmcnt(11) lgkmcnt(6)
v_mfma_f32_32x32x16_bf16 v[8:23], v[216:219], v[192:195], v[8:23]
s_waitcnt lgkmcnt(4)
v_mfma_f32_32x32x16_bf16 v[24:39], v[220:223], v[192:195], v[24:39]
s_waitcnt vmcnt(10) lgkmcnt(2)
v_mfma_f32_32x32x16_bf16 v[8:23], v[200:203], v[196:199], v[8:23]
s_waitcnt lgkmcnt(0)
v_mfma_f32_32x32x16_bf16 v[24:39], v[204:207], v[196:199], v[24:39]
s_nop 9
v_cvt_pk_bf16_f32 v40, v8, v9
v_cvt_pk_bf16_f32 v41, v10, v11
v_cvt_pk_bf16_f32 v42, v12, v13
v_cvt_pk_bf16_f32 v43, v14, v15
s_add_u32 s46, s43, 0
buffer_store_dwordx4 v[40:43], v228, s[32:35], s46 offen
v_cvt_pk_bf16_f32 v44, v16, v17
v_cvt_pk_bf16_f32 v45, v18, v19
v_cvt_pk_bf16_f32 v46, v20, v21
v_cvt_pk_bf16_f32 v47, v22, v23
s_add_u32 s46, s43, 8704
buffer_store_dwordx4 v[44:47], v228, s[32:35], s46 offen
v_cvt_pk_bf16_f32 v48, v24, v25
v_cvt_pk_bf16_f32 v49, v26, v27
v_cvt_pk_bf16_f32 v50, v28, v29
v_cvt_pk_bf16_f32 v51, v30, v31
s_add_u32 s46, s43, 17408
buffer_store_dwordx4 v[48:51], v228, s[32:35], s46 offen
v_cvt_pk_bf16_f32 v52, v32, v33
v_cvt_pk_bf16_f32 v53, v34, v35
v_cvt_pk_bf16_f32 v54, v36, v37
v_cvt_pk_bf16_f32 v55, v38, v39
s_add_u32 s46, s43, 26112
buffer_store_dwordx4 v[52:55], v228, s[32:35], s46 offen
v_dot2_f32_bf16 v232, v40, s50, 0
v_dot2_f32_bf16 v233, v40, v40, 0
v_dot2_f32_bf16 v232, v41, s50, v232
v_dot2_f32_bf16 v233, v41, v41, v233
v_dot2_f32_bf16 v232, v42, s50, v232
v_dot2_f32_bf16 v233, v42, v42, v233
v_dot2_f32_bf16 v232, v43, s50, v232
v_dot2_f32_bf16 v233, v43, v43, v233
v_dot2_f32_bf16 v232, v44, s50, v232
v_dot2_f32_bf16 v233, v44, v44, v233
v_dot2_f32_bf16 v232, v45, s50, v232
v_dot2_f32_bf16 v233, v45, v45, v233
v_dot2_f32_bf16 v232, v46, s50, v232
v_dot2_f32_bf16 v233, v46, v46, v233
v_dot2_f32_bf16 v232, v47, s50, v232
v_dot2_f32_bf16 v233, v47, v47, v233
v_dot2_f32_bf16 v232, v48, s50, v232
v_dot2_f32_bf16 v233, v48, v48, v233
v_dot2_f32_bf16 v232, v49, s50, v232
v_dot2_f32_bf16 v233, v49, v49, v233
v_dot2_f32_bf16 v232, v50, s50, v232
v_dot2_f32_bf16 v233, v50, v50, v233
v_dot2_f32_bf16 v232, v51, s50, v232
v_dot2_f32_bf16 v233, v51, v51, v233
v_dot2_f32_bf16 v232, v52, s50, v232
v_dot2_f32_bf16 v233, v52, v52, v233
v_dot2_f32_bf16 v232, v53, s50, v232
v_dot2_f32_bf16 v233, v53, v53, v233
v_dot2_f32_bf16 v232, v54, s50, v232
v_dot2_f32_bf16 v233, v54, v54, v233
v_dot2_f32_bf16 v232, v55, s50, v232
v_dot2_f32_bf16 v233, v55, v55, v233
s_nop 1
v_mov_b32 v234, v232
v_mov_b32 v235, v233
s_nop 0
v_permlane32_swap_b32 v232, v234
v_permlane32_swap_b32 v233, v235
v_pk_add_f32 v[232:233], v[232:233], v[234:235]
s_mov_b32 exec_hi, 0
buffer_store_dwordx2 v[232:233], v229, s[32:35], s44 offen
s_mov_b64 exec, -1
s_waitcnt vmcnt(5)
s_branch Lst3
Lpf0:
s_waitcnt lgkmcnt(0)
s_add_u32 m0, s57, 0
s_add_u32 s101, s96, 0
buffer_load_dwordx4 v244, s[24:27], s101 offen offset:0  lds
buffer_load_dwordx4 v245, s[24:27], s101 offen offset:1024  lds
buffer_load_dwordx4 v246, s[24:27], s101 offen offset:2048  lds
buffer_load_dwordx4 v247, s[24:27], s101 offen offset:3072  lds
s_add_u32 m0, s57, 8192
s_add_u32 s101, s96, 40960
buffer_load_dwordx4 v244, s[24:27], s101 offen offset:0  lds
buffer_load_dwordx4 v245, s[24:27], s101 offen offset:1024  lds
buffer_load_dwordx4 v246, s[24:27], s101 offen offset:2048  lds
buffer_load_dwordx4 v247, s[24:27], s101 offen offset:3072  lds
s_add_u32 m0, s57, 12288
s_add_u32 s101, s96, 81920
buffer_load_dwordx4 v244, s[24:27], s101 offen offset:0  lds
buffer_load_dwordx4 v245, s[24:27], s101 offen offset:1024  lds
s_add_u32 m0, s57, 4096
s_add_u32 s101, s94, 1658880
buffer_load_dwordx4 v240, s[20:23], s101 offen offset:0  lds
buffer_load_dwordx4 v241, s[20:23], s101 offen offset:1024  lds
buffer_load_dwordx4 v242, s[20:23], s101 offen offset:2048  lds
buffer_load_dwordx4 v243, s[20:23], s101 offen offset:3072  lds
s_add_u32 m0, s57, 14336
s_add_u32 s101, s94, 1880064
buffer_load_dwordx4 v240, s[20:23], s101 offen offset:0  lds
buffer_load_dwordx4 v241, s[20:23], s101 offen offset:1024  lds
buffer_load_dwordx4 v242, s[20:23], s101 offen offset:2048  lds
buffer_load_dwordx4 v243, s[20:23], s101 offen offset:3072  lds
s_add_u32 m0, s57, 18432
s_add_u32 s101, s94, 2101248
buffer_load_dwordx4 v240, s[20:23], s101 offen offset:0  lds
buffer_load_dwordx4 v241, s[20:23], s101 offen offset:1024  lds
v_lshlrev_b32 v25, 7, v0
s_sub_u32 s42, 31, s5
s_lshl_b32 s42, s42, 2
s_add_u32 s42, s42, s6
s_lshl_b32 s42, s42, 13
s_add_u32 s42, s42, 696320
s_add_u32 s3, s42, 0
buffer_load_dword v48, v25, s[32:35], s3 offen
s_cmp_ge_u32 s5, 30
s_cbranch_scc1 Lwb
s_waitcnt vmcnt(0)
Lst3:
s_nop 7
s_nop 7
s_lshl_b32 s47, s6, 5
v_xor_b32 v2, s47, v249
v_add_u32 v122, s57, v2
v_xor_b32 v123, 64, v122
ds_read_b64_tr_b16 a[160:161], v122 offset:0
ds_read_b64_tr_b16 a[162:163], v122 offset:512
ds_read_b64_tr_b16 a[164:165], v123 offset:0
ds_read_b64_tr_b16 a[166:167], v123 offset:512
ds_read_b64_tr_b16 a[168:169], v122 offset:2048
ds_read_b64_tr_b16 a[170:171], v122 offset:2560
ds_read_b64_tr_b16 a[172:173], v123 offset:2048
ds_read_b64_tr_b16 a[174:175], v123 offset:2560
ds_read_b64_tr_b16 a[176:177], v122 offset:8192
ds_read_b64_tr_b16 a[178:179], v122 offset:8704
ds_read_b64_tr_b16 a[180:181], v123 offset:8192
ds_read_b64_tr_b16 a[182:183], v123 offset:8704
ds_read_b64_tr_b16 a[184:185], v122 offset:10240
ds_read_b64_tr_b16 a[186:187], v122 offset:10752
ds_read_b64_tr_b16 a[188:189], v123 offset:10240
ds_read_b64_tr_b16 a[190:191], v123 offset:10752
ds_read_b64_tr_b16 a[192:193], v122 offset:12288
ds_read_b64_tr_b16 a[194:195], v122 offset:12800
ds_read_b64_tr_b16 a[196:197], v123 offset:12288
ds_read_b64_tr_b16 a[198:199], v123 offset:12800
s_waitcnt vmcnt(0) lgkmcnt(0)
s_barrier
s_cmp_lg_u32 s6, 0
s_cbranch_scc1 Lb_36
s_lshl_b32 s3, s5, 2
s_add_u32 s3, s3, 1737088
v_mov_b32 v255, s7
v_mov_b32 v254, 0
s_mov_b64 exec, 1
s_cmp_eq_u32 s90, 0
s_cbranch_scc1 Lb_37
buffer_store_dword v255, v254, s[32:35], s3 offen
s_mov_b64 exec, -1
s_branch Lb_36
Lb_37:
buffer_wbl2 sc1
s_waitcnt vmcnt(0)
buffer_store_dword v255, v254, s[32:35], s3 offen sc0 sc1
s_mov_b64 exec, -1
Lb_36:
v_add_u32 v2, s58, v2
v_xor_b32 v3, 64, v2
v_and_b32 v42, 31, v0
v_lshrrev_b32 v40, 5, v0
v_mul_u32_u24 v41, 10240, v40
v_lshl_add_u32 v36, v42, 3, v41
v_lshlrev_b32 v42, 4, v42
v_mul_u32_u24 v32, 4352, v40
v_add_u32 v32, v32, v42
v_add_u32 v42, 161792, v42
v_mov_b32 v38, v32
v_add_u32 v39, 8704, v32
v_lshlrev_b32 v40, 4, v0
v_add_u32 v41, 0x10000, v40
s_lshl_b32 s42, s100, 11
s_add_u32 s40, s42, 348416
s_cmp_ge_u32 s5, 28
s_cselect_b32 s40, 2130706432, s40
s_mul_i32 s41, s100, 0
s_add_u32 s41, s41, s6
s_and_b32 s41, s41, 3
s_mul_i32 s43, s41, 87040
s_add_u32 s43, s43, s40
s_mul_i32 s44, s6, 10240
s_mul_i32 s41, s6, 8704
s_add_u32 s40, s40, s41
s_mul_i32 s41, s100, 0
s_sub_u32 s49, s40, s41
s_add_u32 s48, s40, s41
s_lshl_b32 s50, s6, 10
s_lshl_b32 s45, s100, 10
s_lshl_b32 s41, s6, 8
s_add_u32 s45, s45, s41
s_add_u32 s45, s45, 1712128
s_mul_i32 s47, s99, 17408
s_add_u32 s47, s47, s42
s_add_u32 s47, s47, 696576
s_sub_u32 s41, s47, 1288192
s_cmp_ge_u32 s99, 34
s_cselect_b32 s47, s41, s47
s_cmp_ge_u32 s99, 54
s_cselect_b32 s47, 2130706432, s47
s_lshl_b32 s51, s6, 9
s_mul_i32 s92, s100, 10
s_lshl_b32 s92, 0x3ff, s92
v_add_u32 v33, 7680, v32
v_add_u32 v34, 15360, v32
v_add_u32 v35, 23040, v32
v_add_u32 v121, s57, v248
v_mov_b32 v4, 0x3f803f80
v_mov_b32 v5, 0x3f803f80
v_mov_b32 v6, 0x3f803f80
v_mov_b32 v7, 0x3f803f80
ds_read_b64_tr_b16 a[120:121], v121 offset:4096
ds_read_b64_tr_b16 a[122:123], v121 offset:4352
ds_read_b64_tr_b16 a[124:125], v121 offset:5120
ds_read_b64_tr_b16 a[126:127], v121 offset:5376
ds_read_b64_tr_b16 a[128:129], v121 offset:6144
ds_read_b64_tr_b16 a[130:131], v121 offset:6400
ds_read_b64_tr_b16 a[132:133], v121 offset:7168
ds_read_b64_tr_b16 a[134:135], v121 offset:7424
s_waitcnt lgkmcnt(6)
v_mfma_f32_32x32x16_bf16 a[224:239], a[120:123], v[4:7], a[224:239]
s_waitcnt lgkmcnt(4)
v_mfma_f32_32x32x16_bf16 a[224:239], a[124:127], v[4:7], a[224:239]
s_waitcnt lgkmcnt(2)
v_mfma_f32_32x32x16_bf16 a[224:239], a[128:131], v[4:7], a[224:239]
s_waitcnt lgkmcnt(0)
v_mfma_f32_32x32x16_bf16 a[224:239], a[132:135], v[4:7], a[224:239]
s_cmp_lg_u32 s6, 0
s_cbranch_scc1 Lq_38
s_mov_b32 s3, 1737088
v_lshlrev_b32 v254, 2, v0
s_mov_b32 exec_hi, 0
buffer_load_dword v255, v254, s[32:35], s3 offen sc1
s_mov_b64 exec, -1
Lq_38:
ds_read_b64_tr_b16 a[136:137], v121 offset:14336
ds_read_b64_tr_b16 a[138:139], v121 offset:14592
ds_read_b64_tr_b16 a[140:141], v121 offset:15360
ds_read_b64_tr_b16 a[142:143], v121 offset:15616
ds_read_b64_tr_b16 a[144:145], v121 offset:16384
ds_read_b64_tr_b16 a[146:147], v121 offset:16640
ds_read_b64_tr_b16 a[148:149], v121 offset:17408
ds_read_b64_tr_b16 a[150:151], v121 offset:17664
ds_read_b64_tr_b16 a[152:153], v121 offset:18432
ds_read_b64_tr_b16 a[154:155], v121 offset:18688
s_waitcnt lgkmcnt(8)
v_mfma_f32_32x32x16_bf16 a[224:239], a[136:139], v[4:7], a[224:239]
ds_read_b64_tr_b16 a[156:157], v121 offset:19456
ds_read_b64_tr_b16 a[158:159], v121 offset:19712
s_waitcnt lgkmcnt(8)
v_mfma_f32_32x32x16_bf16 a[224:239], a[140:143], v[4:7], a[224:239]
s_waitcnt lgkmcnt(6)
v_mfma_f32_32x32x16_bf16 a[224:239], a[144:147], v[4:7], a[224:239]
s_waitcnt lgkmcnt(4)
v_mfma_f32_32x32x16_bf16 a[224:239], a[148:151], v[4:7], a[224:239]
s_waitcnt lgkmcnt(2)
v_mfma_f32_32x32x16_bf16 a[224:239], a[152:155], v[4:7], a[224:239]
s_waitcnt lgkmcnt(0)
v_mfma_f32_32x32x16_bf16 a[224:239], a[156:159], v[4:7], a[224:239]
s_nop 11
v_accvgpr_read_b32 v8, a224
v_accvgpr_read_b32 v9, a225
v_accvgpr_read_b32 v10, a226
v_accvgpr_read_b32 v11, a227
v_accvgpr_read_b32 v12, a228
v_accvgpr_read_b32 v13, a229
v_accvgpr_read_b32 v14, a230
v_accvgpr_read_b32 v15, a231
v_accvgpr_read_b32 v16, a232
v_accvgpr_read_b32 v17, a233
v_accvgpr_read_b32 v18, a234
v_accvgpr_read_b32 v19, a235
v_accvgpr_read_b32 v20, a236
v_accvgpr_read_b32 v21, a237
v_accvgpr_read_b32 v22, a238
v_accvgpr_read_b32 v23, a239
s_cmp_lg_u32 s6, 0
s_cbranch_scc1 La_39
s_mov_b32 s3, 1737088
s_mov_b32 exec_lo, s92
s_mov_b32 exec_hi, 0
s_branch Lac_41
Lap_40:
s_sub_u32 s91, s91, 1
s_cbranch_scc1 Lend
s_waitcnt vmcnt(0)
buffer_load_dword v255, v254, s[32:35], s3 offen sc1
Lac_41:
s_waitcnt vmcnt(0)
s_waitcnt vmcnt(0)
v_cmp_ne_u32 vcc, s7, v255
s_cbranch_vccnz Lap_40
s_mov_b64 exec, -1
s_cmp_lg_u32 s90, 0
s_cbranch_scc1 La_39
buffer_inv sc1
s_waitcnt vmcnt(0)
La_39:
s_add_u32 m0, s57, 0
s_add_u32 s101, s96, 102400
buffer_load_dwordx4 v244, s[24:27], s101 offen offset:0  lds
buffer_load_dwordx4 v245, s[24:27], s101 offen offset:1024  lds
buffer_load_dwordx4 v246, s[24:27], s101 offen offset:2048  lds
buffer_load_dwordx4 v247, s[24:27], s101 offen offset:3072  lds
s_add_u32 m0, s57, 8192
s_add_u32 s101, s96, 143360
buffer_load_dwordx4 v244, s[24:27], s101 offen offset:0  lds
buffer_load_dwordx4 v245, s[24:27], s101 offen offset:1024  lds
buffer_load_dwordx4 v246, s[24:27], s101 offen offset:2048  lds
buffer_load_dwordx4 v247, s[24:27], s101 offen offset:3072  lds
s_add_u32 m0, s57, 12288
s_add_u32 s101, s96, 184320
buffer_load_dwordx4 v244, s[24:27], s101 offen offset:0  lds
buffer_load_dwordx4 v245, s[24:27], s101 offen offset:1024  lds
s_waitcnt lgkmcnt(0)
s_barrier
s_add_u32 m0, s50, 0
s_add_u32 s46, s48, 0
buffer_load_dwordx4 v32, s[32:35], s46 offen sc1 lds
s_add_u32 m0, s50, 4096
s_add_u32 s46, s48, 34816
buffer_load_dwordx4 v32, s[32:35], s46 offen sc1 lds
s_add_u32 m0, s50, 8192
s_add_u32 s46, s48, 69632
buffer_load_dwordx4 v32, s[32:35], s46 offen sc1 lds
s_add_u32 m0, s50, 12288
s_add_u32 s46, s48, 104448
buffer_load_dwordx4 v32, s[32:35], s46 offen sc1 lds
s_add_u32 m0, s50, 16384
s_add_u32 s46, s48, 139264
buffer_load_dwordx4 v32, s[32:35], s46 offen sc1 lds
s_add_u32 m0, s50, 20480
s_add_u32 s46, s49, 174080
buffer_load_dwordx4 v32, s[32:35], s46 offen sc1 lds
s_add_u32 m0, s50, 24576
s_add_u32 s46, s49, 208896
buffer_load_dwordx4 v32, s[32:35], s46 offen sc1 lds
s_add_u32 m0, s50, 28672
s_add_u32 s46, s49, 243712
buffer_load_dwordx4 v32, s[32:35], s46 offen sc1 lds
s_add_u32 m0, s50, 32768
s_add_u32 s46, s49, 278528
buffer_load_dwordx4 v32, s[32:35], s46 offen sc1 lds
s_add_u32 m0, s50, 36864
s_add_u32 s46, s49, 313344
buffer_load_dwordx4 v32, s[32:35], s46 offen sc1 lds
s_add_u32 s46, s45, 0
buffer_load_dwordx2 v[60:61], v36, s[32:35], s46 offen sc1
s_add_u32 s46, s45, 2048
buffer_load_dwordx2 v[62:63], v36, s[32:35], s46 offen sc1
s_add_u32 s46, s45, 4096
buffer_load_dwordx2 v[64:65], v36, s[32:35], s46 offen sc1
s_add_u32 s46, s45, 6144
buffer_load_dwordx2 v[66:67], v36, s[32:35], s46 offen sc1
s_add_u32 s46, s45, 8192
buffer_load_dwordx2 v[68:69], v36, s[32:35], s46 offen sc1
s_waitcnt vmcnt(12)
s_barrier
ds_read_b128 v[76:79], v40 offset:0
ds_read_b128 v[80:83], v40 offset:1024
ds_read_b128 v[84:87], v40 offset:2048
ds_read_b128 v[88:91], v40 offset:3072
ds_read_b128 v[92:95], v40 offset:4096
ds_read_b128 v[96:99], v40 offset:5120
s_waitcnt lgkmcnt(4)
v_mfma_f32_32x32x16_bf16 v[44:59], a[0:3], v[76:79], 0
ds_read_b128 v[100:103], v40 offset:6144
v_mfma_f32_32x32x16_bf16 v[44:59], a[4:7], v[80:83], v[44:59]
ds_read_b128 v[104:107], v40 offset:7168
s_waitcnt lgkmcnt(4)
v_mfma_f32_32x32x16_bf16 v[44:59], a[8:11], v[84:87], v[44:59]
ds_read_b128 v[76:79], v40 offset:8192
s_add_u32 m0, s44, 40960
s_add_u32 s101, s43, 512
buffer_load_dwordx4 v32, s[32:35], s101 offen offset:0 sc1 lds
buffer_load_dwordx4 v33, s[32:35], s101 offen offset:1024 sc1 lds
buffer_load_dwordx4 v34, s[32:35], s101 offen offset:2048 sc1 lds
buffer_load_dwordx4 v35, s[32:35], s101 offen offset:3072 sc1 lds
v_mfma_f32_32x32x16_bf16 v[44:59], a[12:15], v[88:91], v[44:59]
ds_read_b128 v[80:83], v40 offset:9216
ds_read_b64_tr_b16 a[200:201], v122 offset:0
ds_read_b64_tr_b16 a[202:203], v122 offset:512
s_waitcnt lgkmcnt(6)
v_mfma_f32_32x32x16_bf16 v[44:59], a[16:19], v[92:95], v[44:59]
ds_read_b128 v[84:87], v40 offset:10240
ds_read_b64_tr_b16 a[204:205], v123 offset:0
ds_read_b64_tr_b16 a[206:207], v123 offset:512
v_mfma_f32_32x32x16_bf16 v[44:59], a[20:23], v[96:99], v[44:59]
ds_read_b128 v[88:91], v40 offset:11264
s_waitcnt lgkmcnt(8)
v_mfma_f32_32x32x16_bf16 v[44:59], a[24:27], v[100:103], v[44:59]
s_waitcnt vmcnt(9)
s_barrier
ds_read_b128 v[92:95], v40 offset:12288
ds_read_b64_tr_b16 a[208:209], v122 offset:2048
ds_read_b64_tr_b16 a[210:211], v122 offset:2560
v_mfma_f32_32x32x16_bf16 v[44:59], a[28:31], v[104:107], v[44:59]
ds_read_b128 v[96:99], v40 offset:13312
s_add_u32 m0, s44, 45056
s_add_u32 s101, s43, 35328
buffer_load_dwordx4 v32, s[32:35], s101 offen offset:0 sc1 lds
buffer_load_dwordx4 v33, s[32:35], s101 offen offset:1024 sc1 lds
buffer_load_dwordx4 v34, s[32:35], s101 offen offset:2048 sc1 lds
buffer_load_dwordx4 v35, s[32:35], s101 offen offset:3072 sc1 lds
ds_read_b64_tr_b16 a[212:213], v123 offset:2048
ds_read_b64_tr_b16 a[214:215], v123 offset:2560
s_waitcnt lgkmcnt(12)
v_mfma_f32_32x32x16_bf16 v[44:59], a[32:35], v[76:79], v[44:59]
ds_read_b128 v[100:103], v40 offset:14336
v_mfma_f32_32x32x16_bf16 v[44:59], a[36:39], v[80:83], v[44:59]
ds_read_b128 v[104:107], v40 offset:15360
ds_read_b64_tr_b16 a[216:217], v122 offset:8192
ds_read_b64_tr_b16 a[218:219], v122 offset:8704
s_waitcnt lgkmcnt(10)
v_mfma_f32_32x32x16_bf16 v[44:59], a[40:43], v[84:87], v[44:59]
ds_read_b128 v[76:79], v40 offset:16384
ds_read_b64_tr_b16 a[220:221], v123 offset:8192
ds_read_b64_tr_b16 a[222:223], v123 offset:8704
v_mfma_f32_32x32x16_bf16 v[44:59], a[44:47], v[88:91], v[44:59]
ds_read_b128 v[80:83], v40 offset:17408
s_waitcnt lgkmcnt(10)
v_mfma_f32_32x32x16_bf16 v[44:59], a[48:51], v[92:95], v[44:59]
ds_read_b128 v[84:87], v40 offset:18432
s_add_u32 m0, s44, 49152
s_add_u32 s101, s43, 70144
buffer_load_dwordx4 v32, s[32:35], s101 offen offset:0 sc1 lds
buffer_load_dwordx4 v33, s[32:35], s101 offen offset:1024 sc1 lds
ds_read_b64_tr_b16 a[224:225], v122 offset:10240
ds_read_b64_tr_b16 a[226:227], v122 offset:10752
s_waitcnt vmcnt(13)
v_add_f32 v60, v60, v62
v_add_f32 v61, v61, v63
v_mfma_f32_32x32x16_bf16 v[44:59], a[52:55], v[96:99], v[44:59]
ds_read_b128 v[88:91], v40 offset:19456
ds_read_b64_tr_b16 a[228:229], v123 offset:10240
ds_read_b64_tr_b16 a[230:231], v123 offset:10752
s_waitcnt vmcnt(11)
v_add_f32 v64, v64, v66
v_add_f32 v65, v65, v67
s_waitcnt lgkmcnt(12)
v_mfma_f32_32x32x16_bf16 v[44:59], a[56:59], v[100:103], v[44:59]
ds_read_b128 v[92:95], v40 offset:20480
v_mov_b32 v143, v38
s_waitcnt vmcnt(10)
v_add_f32 v60, v60, v68
v_add_f32 v61, v61, v69
v_mfma_f32_32x32x16_bf16 v[44:59], a[60:63], v[104:107], v[44:59]
ds_read_b128 v[96:99], v40 offset:21504
ds_read_b64_tr_b16 a[232:233], v122 offset:12288
ds_read_b64_tr_b16 a[234:235], v122 offset:12800
v_mov_b32 v253, s7
v_add_f32 v60, v60, v64
v_add_f32 v61, v61, v65
s_waitcnt lgkmcnt(10)
v_mfma_f32_32x32x16_bf16 v[44:59], a[64:67], v[76:79], v[44:59]
ds_read_b128 v[100:103], v40 offset:22528
ds_read_b64_tr_b16 a[236:237], v123 offset:12288
ds_read_b64_tr_b16 a[238:239], v123 offset:12800
v_lshlrev_b32 v254, 2, v0
v_mov_b32 v62, v60
v_mov_b32 v63, v61
v_mfma_f32_32x32x16_bf16 v[44:59], a[68:71], v[80:83], v[44:59]
ds_read_b128 v[104:107], v40 offset:23552
s_lshl_b32 s59, s100, 6
v_add_u32 v68, s51, v42
v_permlane32_swap_b32 v60, v62
s_waitcnt lgkmcnt(10)
v_mfma_f32_32x32x16_bf16 v[44:59], a[72:75], v[84:87], v[44:59]
ds_read_b128 v[76:79], v40 offset:24576
s_add_u32 s59, s59, s99
v_permlane32_swap_b32 v61, v63
v_add_f32 v60, v60, v62
v_mfma_f32_32x32x16_bf16 v[44:59], a[76:79], v[88:91], v[44:59]
ds_read_b128 v[80:83], v40 offset:25600
s_lshl_b32 s59, s59, 2
v_add_f32 v61, v61, v63
v_mul_f32 v64, 0xbacccccd, v60
s_waitcnt lgkmcnt(8)
v_mfma_f32_32x32x16_bf16 v[44:59], a[80:83], v[92:95], v[44:59]
ds_read_b128 v[84:87], v40 offset:26624
s_add_u32 s59, s59, 1737728
v_mul_f32 v61, 0x3acccccd, v61
v_fma_f32 v61, -v64, v64, v61
v_mfma_f32_32x32x16_bf16 v[44:59], a[84:87], v[96:99], v[44:59]
ds_read_b128 v[88:91], v40 offset:27648
s_mul_i32 s41, s6, 27
v_max_f32 v61, 0, v61
v_add_f32 v61, 0x3727c5ac, v61
s_waitcnt lgkmcnt(4)
v_mfma_f32_32x32x16_bf16 v[44:59], a[88:91], v[100:103], v[44:59]
ds_read_b128 v[92:95], v40 offset:28672
s_lshr_b32 s41, s41, 1
v_rsq_f32 v60, v61
s_nop 0
v_mul_f32 v66, v61, v60
v_mfma_f32_32x32x16_bf16 v[44:59], a[92:95], v[104:107], v[44:59]
ds_read_b128 v[96:99], v40 offset:29696
s_mov_b64 s[48:49], 0x3fff
v_mul_f32 v65, 0xbfb8aa3b, v60
ds_write_b128 v68, v[64:67]
s_waitcnt lgkmcnt(5)
v_mfma_f32_32x32x16_bf16 v[44:59], a[96:99], v[76:79], v[44:59]
ds_read_b128 v[100:103], v40 offset:30720
s_lshl_b64 s[48:49], s[48:49], s41
v_mfma_f32_32x32x16_bf16 v[44:59], a[100:103], v[80:83], v[44:59]
ds_read_b128 v[104:107], v40 offset:31744
s_lshl_b32 s55, s98, 8
s_waitcnt lgkmcnt(5)
v_mfma_f32_32x32x16_bf16 v[44:59], a[104:107], v[84:87], v[44:59]
ds_read_b128 v[76:79], v40 offset:32768
s_add_u32 s55, s55, 1737728
v_mfma_f32_32x32x16_bf16 v[44:59], a[108:111], v[88:91], v[44:59]
ds_read_b128 v[80:83], v40 offset:33792
s_lshl_b32 s40, s98, 7
s_waitcnt lgkmcnt(5)
v_mfma_f32_32x32x16_bf16 v[44:59], a[112:115], v[92:95], v[44:59]
ds_read_b128 v[84:87], v40 offset:34816
s_cmp_eq_u32 s98, 2
s_cselect_b32 s40, -32, s40
s_cselect_b32 s41, 128, 32
s_cselect_b64 s[56:57], 0, s[48:49]
v_mfma_f32_32x32x16_bf16 v[44:59], a[116:119], v[96:99], v[44:59]
ds_read_b128 v[88:91], v40 offset:35840
s_mul_i32 s52, s6, 235008
s_waitcnt lgkmcnt(4)
v_mfma_f32_32x32x16_bf16 v[44:59], a[120:123], v[100:103], v[44:59]
ds_read_b128 v[92:95], v40 offset:36864
s_add_u32 s52, s52, 696576
v_mfma_f32_32x32x16_bf16 v[44:59], a[124:127], v[104:107], v[44:59]
ds_read_b128 v[96:99], v40 offset:37888
s_cmp_eq_u32 s6, 3
s_cselect_b32 s42, 1288192, 0
s_sub_u32 s52, s52, s42
s_waitcnt lgkmcnt(4)
v_mfma_f32_32x32x16_bf16 v[44:59], a[128:131], v[76:79], v[44:59]
ds_read_b128 v[100:103], v40 offset:38912
s_cmp_eq_u32 s6, 2
s_cselect_b32 s93, 1288192, 0
v_mfma_f32_32x32x16_bf16 v[44:59], a[132:135], v[80:83], v[44:59]
ds_read_b128 v[104:107], v40 offset:39936
s_lshl_b32 s42, s40, 4
s_waitcnt lgkmcnt(4)
v_mfma_f32_32x32x16_bf16 v[44:59], a[136:139], v[84:87], v[44:59]
s_waitcnt vmcnt(0)
s_waitcnt lgkmcnt(0)
s_barrier
ds_read_b128 v[24:27], v42 offset:0
ds_read_b128 v[76:79], v40 offset:40960
s_add_u32 s52, s52, s42
v_mfma_f32_32x32x16_bf16 v[44:59], a[140:143], v[88:91], v[44:59]
ds_read_b128 v[80:83], v40 offset:41984
s_add_u32 m0, s44, 81920
s_add_u32 s101, s43, 1024
buffer_load_dwordx4 v32, s[32:35], s101 offen offset:0 sc1 lds
buffer_load_dwordx4 v33, s[32:35], s101 offen offset:1024 sc1 lds
buffer_load_dwordx4 v34, s[32:35], s101 offen offset:2048 sc1 lds
buffer_load_dwordx4 v35, s[32:35], s101 offen offset:3072 sc1 lds
s_lshl_b32 s42, s41, 4
v_mfma_f32_32x32x16_bf16 v[44:59], a[144:147], v[92:95], v[44:59]
ds_read_b128 v[84:87], v40 offset:43008
s_add_u32 s53, s52, s42
v_mfma_f32_32x32x16_bf16 v[44:59], a[148:151], v[96:99], v[44:59]
ds_read_b128 v[88:91], v40 offset:44032
s_add_u32 m0, s58, 4096
s_add_u32 s101, s96, 204800
buffer_load_dwordx4 v244, s[24:27], s101 offen offset:0  lds
buffer_load_dwordx4 v245, s[24:27], s101 offen offset:1024  lds
s_add_u32 s54, s53, s42
v_mfma_f32_32x32x16_bf16 v[44:59], a[152:155], v[100:103], v[44:59]
ds_read_b128 v[92:95], v40 offset:45056
s_cmp_eq_u32 s98, 2
s_cselect_b32 s52, 2130706432, s52
v_mfma_f32_32x32x16_bf16 v[44:59], a[156:159], v[104:107], v[44:59]
ds_read_b128 v[96:99], v40 offset:46080
s_waitcnt lgkmcnt(4)
v_mfma_f32_32x32x16_bf16 v[60:75], a[0:3], v[76:79], 0
ds_read_b128 v[100:103], v40 offset:47104
s_add_u32 m0, s44, 86016
s_add_u32 s101, s43, 35840
buffer_load_dwordx4 v32, s[32:35], s101 offen offset:0 sc1 lds
buffer_load_dwordx4 v33, s[32:35], s101 offen offset:1024 sc1 lds
buffer_load_dwordx4 v34, s[32:35], s101 offen offset:2048 sc1 lds
buffer_load_dwordx4 v35, s[32:35], s101 offen offset:3072 sc1 lds
v_mfma_f32_32x32x16_bf16 v[60:75], a[4:7], v[80:83], v[60:75]
ds_read_b128 v[104:107], v40 offset:48128
s_waitcnt lgkmcnt(4)
v_mfma_f32_32x32x16_bf16 v[60:75], a[8:11], v[84:87], v[60:75]
ds_read_b128 v[76:79], v40 offset:49152
v_fma_f32 v44, v24, v8, v44
v_fma_f32 v45, v24, v9, v45
v_fma_f32 v46, v24, v10, v46
v_mfma_f32_32x32x16_bf16 v[60:75], a[12:15], v[88:91], v[60:75]
ds_read_b128 v[80:83], v40 offset:50176
s_add_u32 m0, s58, 6144
s_add_u32 s101, s96, 225280
buffer_load_dwordx4 v244, s[24:27], s101 offen offset:0  lds
buffer_load_dwordx4 v245, s[24:27], s101 offen offset:1024  lds
v_fma_f32 v47, v24, v11, v47
v_mul_f32 v108, v25, v44
v_mul_f32 v109, v25, v45
s_waitcnt lgkmcnt(4)
v_mfma_f32_32x32x16_bf16 v[60:75], a[16:19], v[92:95], v[60:75]
ds_read_b128 v[84:87], v40 offset:51200
v_mul_f32 v110, v25, v46
v_mul_f32 v111, v25, v47
v_mfma_f32_32x32x16_bf16 v[60:75], a[20:23], v[96:99], v[60:75]
ds_read_b128 v[88:91], v40 offset:52224
s_add_u32 m0, s44, 90112
s_add_u32 s101, s43, 70656
buffer_load_dwordx4 v32, s[32:35], s101 offen offset:0 sc1 lds
buffer_load_dwordx4 v33, s[32:35], s101 offen offset:1024 sc1 lds
v_exp_f32 v108, v108
v_exp_f32 v109, v109
v_exp_f32 v110, v110
s_waitcnt lgkmcnt(4)
v_mfma_f32_32x32x16_bf16 v[60:75], a[24:27], v[100:103], v[60:75]
ds_read_b128 v[92:95], v40 offset:53248
v_exp_f32 v111, v111
v_fma_f32 v108, v108, v26, v26
v_fma_f32 v109, v109, v26, v26
v_mfma_f32_32x32x16_bf16 v[60:75], a[28:31], v[104:107], v[60:75]
ds_read_b128 v[96:99], v40 offset:54272
v_fma_f32 v110, v110, v26, v26
v_fma_f32 v111, v111, v26, v26
v_rcp_f32 v108, v108
s_waitcnt lgkmcnt(4)
v_mfma_f32_32x32x16_bf16 v[60:75], a[32:35], v[76:79], v[60:75]
ds_read_b128 v[100:103], v40 offset:55296
v_rcp_f32 v109, v109
v_rcp_f32 v110, v110
v_mfma_f32_32x32x16_bf16 v[60:75], a[36:39], v[80:83], v[60:75]
ds_read_b128 v[104:107], v40 offset:56320
s_add_u32 m0, s58, 0
s_add_u32 s101, s96, 245760
buffer_load_dwordx4 v244, s[24:27], s101 offen offset:0  lds
buffer_load_dwordx4 v245, s[24:27], s101 offen offset:1024  lds
v_rcp_f32 v111, v111
v_mul_f32 v108, v108, v44
v_mul_f32 v109, v109, v45
s_waitcnt lgkmcnt(4)
v_mfma_f32_32x32x16_bf16 v[60:75], a[40:43], v[84:87], v[60:75]
ds_read_b128 v[76:79], v40 offset:57344
v_mul_f32 v110, v110, v46
v_mul_f32 v111, v111, v47
v_cvt_pk_bf16_f32 v124, v108, v109
v_mfma_f32_32x32x16_bf16 v[60:75], a[44:47], v[88:91], v[60:75]
ds_read_b128 v[80:83], v40 offset:58368
v_cvt_pk_bf16_f32 v125, v110, v111
v_fma_f32 v48, v24, v12, v48
v_fma_f32 v49, v24, v13, v49
s_waitcnt lgkmcnt(4)
v_mfma_f32_32x32x16_bf16 v[60:75], a[48:51], v[92:95], v[60:75]
ds_read_b128 v[84:87], v40 offset:59392
v_fma_f32 v50, v24, v14, v50
v_fma_f32 v51, v24, v15, v51
v_mfma_f32_32x32x16_bf16 v[60:75], a[52:55], v[96:99], v[60:75]
ds_read_b128 v[88:91], v40 offset:60416
v_mul_f32 v112, v25, v48
v_mul_f32 v113, v25, v49
v_mul_f32 v114, v25, v50
s_waitcnt lgkmcnt(4)
v_mfma_f32_32x32x16_bf16 v[60:75], a[56:59], v[100:103], v[60:75]
ds_read_b128 v[92:95], v40 offset:61440
v_mul_f32 v115, v25, v51
v_exp_f32 v112, v112
v_exp_f32 v113, v113
v_mfma_f32_32x32x16_bf16 v[60:75], a[60:63], v[104:107], v[60:75]
ds_read_b128 v[96:99], v40 offset:62464
v_exp_f32 v114, v114
v_exp_f32 v115, v115
v_fma_f32 v112, v112, v26, v26
s_waitcnt lgkmcnt(4)
v_mfma_f32_32x32x16_bf16 v[60:75], a[64:67], v[76:79], v[60:75]
ds_read_b128 v[100:103], v40 offset:63488
s_add_u32 m0, s58, 2048
s_add_u32 s101, s96, 266240
buffer_load_dwordx4 v244, s[24:27], s101 offen offset:0  lds
buffer_load_dwordx4 v245, s[24:27], s101 offen offset:1024  lds
v_fma_f32 v113, v113, v26, v26
v_fma_f32 v114, v114, v26, v26
v_mfma_f32_32x32x16_bf16 v[60:75], a[68:71], v[80:83], v[60:75]
ds_read_b128 v[104:107], v40 offset:64512
v_fma_f32 v115, v115, v26, v26
v_rcp_f32 v112, v112
v_rcp_f32 v113, v113
s_waitcnt lgkmcnt(4)
v_mfma_f32_32x32x16_bf16 v[60:75], a[72:75], v[84:87], v[60:75]
ds_read_b128 v[76:79], v41 offset:0
v_rcp_f32 v114, v114
v_rcp_f32 v115, v115
v_mul_f32 v112, v112, v48
v_mfma_f32_32x32x16_bf16 v[60:75], a[76:79], v[88:91], v[60:75]
ds_read_b128 v[80:83], v41 offset:1024
s_waitcnt vmcnt(12)
ds_read_b64_tr_b16 a[240:241], v2 offset:4096
ds_read_b64_tr_b16 a[242:243], v2 offset:4608
v_mul_f32 v113, v113, v49
v_mul_f32 v114, v114, v50
v_mul_f32 v115, v115, v51
s_waitcnt lgkmcnt(6)
v_mfma_f32_32x32x16_bf16 v[60:75], a[80:83], v[92:95], v[60:75]
ds_read_b128 v[84:87], v41 offset:2048
ds_read_b64_tr_b16 a[244:245], v3 offset:4096
ds_read_b64_tr_b16 a[246:247], v3 offset:4608
v_cvt_pk_bf16_f32 v126, v112, v113
v_cvt_pk_bf16_f32 v127, v114, v115
v_mfma_f32_32x32x16_bf16 v[60:75], a[84:87], v[96:99], v[60:75]
ds_read_b128 v[88:91], v41 offset:3072
buffer_store_dwordx4 v[124:127], v38, s[32:35], s47 offen offset:0
v_fma_f32 v52, v24, v16, v52
v_fma_f32 v53, v24, v17, v53
s_waitcnt lgkmcnt(8)
v_mfma_f32_32x32x16_bf16 v[60:75], a[88:91], v[100:103], v[60:75]
ds_read_b128 v[92:95], v41 offset:4096
s_waitcnt lgkmcnt(2)
s_add_u32 m0, s58, 4096
s_add_u32 s101, s96, 286720
buffer_load_dwordx4 v244, s[24:27], s101 offen offset:0  lds
buffer_load_dwordx4 v245, s[24:27], s101 offen offset:1024  lds
v_fma_f32 v54, v24, v18, v54
v_fma_f32 v55, v24, v19, v55
v_mul_f32 v116, v25, v52
v_mfma_f32_32x32x16_bf16 v[60:75], a[92:95], v[104:107], v[60:75]
ds_read_b128 v[96:99], v41 offset:5120
v_mul_f32 v117, v25, v53
v_mul_f32 v118, v25, v54
v_mul_f32 v119, v25, v55
v_mfma_f32_32x32x16_bf16 v[60:75], a[96:99], v[76:79], v[60:75]
ds_read_b128 v[100:103], v41 offset:6144
v_exp_f32 v116, v116
v_exp_f32 v117, v117
v_mfma_f32_32x32x16_bf16 v[60:75], a[100:103], v[80:83], v[60:75]
ds_read_b128 v[104:107], v41 offset:7168
v_exp_f32 v118, v118
v_exp_f32 v119, v119
v_fma_f32 v116, v116, v26, v26
s_waitcnt lgkmcnt(4)
v_mfma_f32_32x32x16_bf16 v[60:75], a[104:107], v[84:87], v[60:75]
ds_read_b128 v[76:79], v41 offset:8192
s_waitcnt vmcnt(9)
ds_read_b64_tr_b16 a[248:249], v2 offset:6144
ds_read_b64_tr_b16 a[250:251], v2 offset:6656
v_fma_f32 v117, v117, v26, v26
v_fma_f32 v118, v118, v26, v26
v_fma_f32 v119, v119, v26, v26
v_mfma_f32_32x32x16_bf16 v[60:75], a[108:111], v[88:91], v[60:75]
ds_read_b128 v[80:83], v41 offset:9216
ds_read_b64_tr_b16 a[252:253], v3 offset:6144
ds_read_b64_tr_b16 a[254:255], v3 offset:6656
v_rcp_f32 v116, v116
v_rcp_f32 v117, v117
v_rcp_f32 v118, v118
s_waitcnt lgkmcnt(8)
v_mfma_f32_32x32x16_bf16 v[60:75], a[112:115], v[92:95], v[60:75]
ds_read_b128 v[84:87], v41 offset:10240
v_rcp_f32 v119, v119
v_mul_f32 v116, v116, v52
v_mfma_f32_32x32x16_bf16 v[60:75], a[116:119], v[96:99], v[60:75]
ds_read_b128 v[88:91], v41 offset:11264
s_waitcnt lgkmcnt(2)
s_add_u32 m0, s58, 6144
s_add_u32 s101, s96, 307200
buffer_load_dwordx4 v244, s[24:27], s101 offen offset:0  lds
buffer_load_dwordx4 v245, s[24:27], s101 offen offset:1024  lds
v_mul_f32 v117, v117, v53
v_mul_f32 v118, v118, v54
v_mul_f32 v119, v119, v55
v_mfma_f32_32x32x16_bf16 v[60:75], a[120:123], v[100:103], v[60:75]
ds_read_b128 v[92:95], v41 offset:12288
v_cvt_pk_bf16_f32 v128, v116, v117
v_cvt_pk_bf16_f32 v129, v118, v119
v_fma_f32 v56, v24, v20, v56
v_mfma_f32_32x32x16_bf16 v[60:75], a[124:127], v[104:107], v[60:75]
ds_read_b128 v[96:99], v41 offset:13312
v_fma_f32 v57, v24, v21, v57
v_fma_f32 v58, v24, v22, v58
v_fma_f32 v59, v24, v23, v59
v_mfma_f32_32x32x16_bf16 v[60:75], a[128:131], v[76:79], v[60:75]
ds_read_b128 v[100:103], v41 offset:14336
s_waitcnt vmcnt(7)
ds_read_b64_tr_b16 v[144:145], v2 offset:0
ds_read_b64_tr_b16 v[146:147], v2 offset:512
v_mul_f32 v120, v25, v56
v_mul_f32 v121, v25, v57
v_mfma_f32_32x32x16_bf16 v[60:75], a[132:135], v[80:83], v[60:75]
ds_read_b128 v[104:107], v41 offset:15360
ds_read_b64_tr_b16 v[148:149], v3 offset:0
ds_read_b64_tr_b16 v[150:151], v3 offset:512
v_mul_f32 v122, v25, v58
v_mul_f32 v123, v25, v59
v_exp_f32 v120, v120
s_waitcnt lgkmcnt(8)
v_mfma_f32_32x32x16_bf16 v[60:75], a[136:139], v[84:87], v[60:75]
s_barrier
ds_read_b128 v[28:31], v42 offset:512
ds_read_b128 v[76:79], v41 offset:16384
v_exp_f32 v121, v121
v_exp_f32 v122, v122
v_exp_f32 v123, v123
v_mfma_f32_32x32x16_bf16 v[60:75], a[140:143], v[88:91], v[60:75]
ds_read_b128 v[80:83], v41 offset:17408
s_waitcnt lgkmcnt(3)
s_add_u32 m0, s58, 0
s_add_u32 s101, s96, 327680
buffer_load_dwordx4 v244, s[24:27], s101 offen offset:0  lds
buffer_load_dwordx4 v245, s[24:27], s101 offen offset:1024  lds
v_fma_f32 v120, v120, v26, v26
v_fma_f32 v121, v121, v26, v26
v_fma_f32 v122, v122, v26, v26
v_mfma_f32_32x32x16_bf16 v[60:75], a[144:147], v[92:95], v[60:75]
ds_read_b128 v[84:87], v41 offset:18432
s_add_u32 m0, s44, 0
s_add_u32 s101, s43, 1536
buffer_load_dwordx4 v32, s[32:35], s101 offen offset:0 sc1 lds
buffer_load_dwordx4 v33, s[32:35], s101 offen offset:1024 sc1 lds
buffer_load_dwordx4 v34, s[32:35], s101 offen offset:2048 sc1 lds
buffer_load_dwordx4 v35, s[32:35], s101 offen offset:3072 sc1 lds
v_fma_f32 v123, v123, v26, v26
v_rcp_f32 v120, v120
v_mfma_f32_32x32x16_bf16 v[60:75], a[148:151], v[96:99], v[60:75]
ds_read_b128 v[88:91], v41 offset:19456
v_rcp_f32 v121, v121
v_rcp_f32 v122, v122
v_rcp_f32 v123, v123
v_mfma_f32_32x32x16_bf16 v[60:75], a[152:155], v[100:103], v[60:75]
ds_read_b128 v[92:95], v41 offset:20480
v_mul_f32 v120, v120, v56
v_mul_f32 v121, v121, v57
v_mul_f32 v122, v122, v58
v_mfma_f32_32x32x16_bf16 v[60:75], a[156:159], v[104:107], v[60:75]
ds_read_b128 v[96:99], v41 offset:21504
s_waitcnt vmcnt(11)
ds_read_b64_tr_b16 v[152:153], v2 offset:2048
ds_read_b64_tr_b16 v[154:155], v2 offset:2560
v_mul_f32 v123, v123, v59
v_cvt_pk_bf16_f32 v130, v120, v121
v_cvt_pk_bf16_f32 v131, v122, v123
buffer_store_dwordx4 v[128:131], v39, s[32:35], s47 offen offset:0
s_waitcnt lgkmcnt(6)
v_mfma_f32_32x32x16_bf16 v[44:59], a[0:3], v[76:79], 0
ds_read_b128 v[100:103], v41 offset:22528
ds_read_b64_tr_b16 v[156:157], v3 offset:2048
ds_read_b64_tr_b16 v[158:159], v3 offset:2560
v_mfma_f32_32x32x16_bf16 v[44:59], a[4:7], v[80:83], v[44:59]
ds_read_b128 v[104:107], v41 offset:23552
s_add_u32 m0, s44, 4096
s_add_u32 s101, s43, 36352
buffer_load_dwordx4 v32, s[32:35], s101 offen offset:0 sc1 lds
buffer_load_dwordx4 v33, s[32:35], s101 offen offset:1024 sc1 lds
buffer_load_dwordx4 v34, s[32:35], s101 offen offset:2048 sc1 lds
buffer_load_dwordx4 v35, s[32:35], s101 offen offset:3072 sc1 lds
s_waitcnt lgkmcnt(8)
v_mfma_f32_32x32x16_bf16 v[44:59], a[8:11], v[84:87], v[44:59]
ds_read_b128 v[76:79], v41 offset:24576
s_waitcnt lgkmcnt(2)
s_add_u32 m0, s58, 2048
s_add_u32 s101, s96, 348160
buffer_load_dwordx4 v244, s[24:27], s101 offen offset:0  lds
buffer_load_dwordx4 v245, s[24:27], s101 offen offset:1024  lds
v_fma_f32 v60, v28, v8, v60
v_fma_f32 v61, v28, v9, v61
v_fma_f32 v62, v28, v10, v62
v_mfma_f32_32x32x16_bf16 v[44:59], a[12:15], v[88:91], v[44:59]
ds_read_b128 v[80:83], v41 offset:25600
v_fma_f32 v63, v28, v11, v63
v_mul_f32 v108, v29, v60
v_mul_f32 v109, v29, v61
v_mfma_f32_32x32x16_bf16 v[44:59], a[16:19], v[92:95], v[44:59]
ds_read_b128 v[84:87], v41 offset:26624
v_mul_f32 v110, v29, v62
v_mul_f32 v111, v29, v63
v_mfma_f32_32x32x16_bf16 v[44:59], a[20:23], v[96:99], v[44:59]
ds_read_b128 v[88:91], v41 offset:27648
s_waitcnt vmcnt(15)
ds_read_b64_tr_b16 v[160:161], v2 offset:4096
ds_read_b64_tr_b16 v[162:163], v2 offset:4608
v_exp_f32 v108, v108
v_exp_f32 v109, v109
v_exp_f32 v110, v110
s_waitcnt lgkmcnt(6)
v_mfma_f32_32x32x16_bf16 v[44:59], a[24:27], v[100:103], v[44:59]
ds_read_b128 v[92:95], v41 offset:28672
s_add_u32 m0, s44, 8192
s_add_u32 s101, s43, 71168
buffer_load_dwordx4 v32, s[32:35], s101 offen offset:0 sc1 lds
buffer_load_dwordx4 v33, s[32:35], s101 offen offset:1024 sc1 lds
ds_read_b64_tr_b16 v[164:165], v3 offset:4096
ds_read_b64_tr_b16 v[166:167], v3 offset:4608
v_exp_f32 v111, v111
v_fma_f32 v108, v108, v30, v30
v_fma_f32 v109, v109, v30, v30
v_mfma_f32_32x32x16_bf16 v[44:59], a[28:31], v[104:107], v[44:59]
ds_read_b128 v[96:99], v41 offset:29696
v_fma_f32 v110, v110, v30, v30
v_fma_f32 v111, v111, v30, v30
v_rcp_f32 v108, v108
s_waitcnt lgkmcnt(8)
v_mfma_f32_32x32x16_bf16 v[44:59], a[32:35], v[76:79], v[44:59]
ds_read_b128 v[100:103], v41 offset:30720
s_waitcnt lgkmcnt(2)
s_add_u32 m0, s58, 4096
s_add_u32 s101, s96, 368640
buffer_load_dwordx4 v244, s[24:27], s101 offen offset:0  lds
buffer_load_dwordx4 v245, s[24:27], s101 offen offset:1024  lds
v_rcp_f32 v109, v109
v_rcp_f32 v110, v110
v_mfma_f32_32x32x16_bf16 v[44:59], a[36:39], v[80:83], v[44:59]
ds_read_b128 v[104:107], v41 offset:31744
v_rcp_f32 v111, v111
v_mul_f32 v108, v108, v60
v_mul_f32 v109, v109, v61
v_mfma_f32_32x32x16_bf16 v[44:59], a[40:43], v[84:87], v[44:59]
ds_read_b128 v[76:79], v41 offset:32768
v_mul_f32 v110, v110, v62
v_mul_f32 v111, v111, v63
v_cvt_pk_bf16_f32 v124, v108, v109
v_mfma_f32_32x32x16_bf16 v[44:59], a[44:47], v[88:91], v[44:59]
ds_read_b128 v[80:83], v41 offset:33792
s_waitcnt vmcnt(17)
ds_read_b64_tr_b16 v[168:169], v2 offset:6144
ds_read_b64_tr_b16 v[170:171], v2 offset:6656
v_cvt_pk_bf16_f32 v125, v110, v111
v_fma_f32 v64, v28, v12, v64
v_fma_f32 v65, v28, v13, v65
s_waitcnt lgkmcnt(6)
v_mfma_f32_32x32x16_bf16 v[44:59], a[48:51], v[92:95], v[44:59]
ds_read_b128 v[84:87], v41 offset:34816
ds_read_b64_tr_b16 v[172:173], v3 offset:6144
ds_read_b64_tr_b16 v[174:175], v3 offset:6656
v_fma_f32 v66, v28, v14, v66
v_fma_f32 v67, v28, v15, v67
v_mfma_f32_32x32x16_bf16 v[44:59], a[52:55], v[96:99], v[44:59]
ds_read_b128 v[88:91], v41 offset:35840
v_mul_f32 v112, v29, v64
v_mul_f32 v113, v29, v65
v_mul_f32 v114, v29, v66
s_waitcnt lgkmcnt(8)
v_mfma_f32_32x32x16_bf16 v[44:59], a[56:59], v[100:103], v[44:59]
ds_read_b128 v[92:95], v41 offset:36864
s_waitcnt lgkmcnt(2)
s_add_u32 m0, s58, 6144
s_add_u32 s101, s96, 389120
buffer_load_dwordx4 v244, s[24:27], s101 offen offset:0  lds
buffer_load_dwordx4 v245, s[24:27], s101 offen offset:1024  lds
v_mul_f32 v115, v29, v67
v_exp_f32 v112, v112
v_exp_f32 v113, v113
v_mfma_f32_32x32x16_bf16 v[44:59], a[60:63], v[104:107], v[44:59]
ds_read_b128 v[96:99], v41 offset:37888
v_exp_f32 v114, v114
v_exp_f32 v115, v115
v_fma_f32 v112, v112, v30, v30
v_mfma_f32_32x32x16_bf16 v[44:59], a[64:67], v[76:79], v[44:59]
ds_read_b128 v[100:103], v41 offset:38912
v_fma_f32 v113, v113, v30, v30
v_fma_f32 v114, v114, v30, v30
v_mfma_f32_32x32x16_bf16 v[44:59], a[68:71], v[80:83], v[44:59]
ds_read_b128 v[104:107], v41 offset:39936
v_fma_f32 v115, v115, v30, v30
v_rcp_f32 v112, v112
v_rcp_f32 v113, v113
s_waitcnt lgkmcnt(4)
v_mfma_f32_32x32x16_bf16 v[44:59], a[72:75], v[84:87], v[44:59]
ds_read_b128 v[76:79], v41 offset:40960
s_waitcnt vmcnt(17)
ds_read_b64_tr_b16 v[176:177], v2 offset:0
ds_read_b64_tr_b16 v[178:179], v2 offset:512
v_rcp_f32 v114, v114
v_rcp_f32 v115, v115
v_mul_f32 v112, v112, v64
v_mfma_f32_32x32x16_bf16 v[44:59], a[76:79], v[88:91], v[44:59]
ds_read_b128 v[80:83], v41 offset:41984
ds_read_b64_tr_b16 v[180:181], v3 offset:0
ds_read_b64_tr_b16 v[182:183], v3 offset:512
v_mul_f32 v113, v113, v65
v_mul_f32 v114, v114, v66
v_mul_f32 v115, v115, v67
s_waitcnt lgkmcnt(8)
v_mfma_f32_32x32x16_bf16 v[44:59], a[80:83], v[92:95], v[44:59]
ds_read_b128 v[84:87], v41 offset:43008
v_cvt_pk_bf16_f32 v126, v112, v113
v_cvt_pk_bf16_f32 v127, v114, v115
v_mfma_f32_32x32x16_bf16 v[44:59], a[84:87], v[96:99], v[44:59]
ds_read_b128 v[88:91], v41 offset:44032
s_waitcnt lgkmcnt(2)
s_add_u32 m0, s58, 0
s_add_u32 s101, s96, 409600
buffer_load_dwordx4 v244, s[24:27], s101 offen offset:0  lds
buffer_load_dwordx4 v245, s[24:27], s101 offen offset:1024  lds
buffer_store_dwordx4 v[124:127], v38, s[32:35], s47 offen offset:512
v_fma_f32 v68, v28, v16, v68
v_fma_f32 v69, v28, v17, v69
v_mfma_f32_32x32x16_bf16 v[44:59], a[88:91], v[100:103], v[44:59]
ds_read_b128 v[92:95], v41 offset:45056
v_fma_f32 v70, v28, v18, v70
v_fma_f32 v71, v28, v19, v71
v_mul_f32 v116, v29, v68
v_mfma_f32_32x32x16_bf16 v[44:59], a[92:95], v[104:107], v[44:59]
ds_read_b128 v[96:99], v41 offset:46080
v_mul_f32 v117, v29, v69
v_mul_f32 v118, v29, v70
v_mul_f32 v119, v29, v71
v_mfma_f32_32x32x16_bf16 v[44:59], a[96:99], v[76:79], v[44:59]
ds_read_b128 v[100:103], v41 offset:47104
s_waitcnt vmcnt(9)
ds_read_b64_tr_b16 v[184:185], v2 offset:2048
ds_read_b64_tr_b16 v[186:187], v2 offset:2560
v_exp_f32 v116, v116
v_exp_f32 v117, v117
v_mfma_f32_32x32x16_bf16 v[44:59], a[100:103], v[80:83], v[44:59]
ds_read_b128 v[104:107], v41 offset:48128
ds_read_b64_tr_b16 v[188:189], v3 offset:2048
ds_read_b64_tr_b16 v[190:191], v3 offset:2560
v_exp_f32 v118, v118
v_exp_f32 v119, v119
v_fma_f32 v116, v116, v30, v30
s_waitcnt lgkmcnt(8)
v_mfma_f32_32x32x16_bf16 v[44:59], a[104:107], v[84:87], v[44:59]
ds_read_b128 v[76:79], v41 offset:49152
v_fma_f32 v117, v117, v30, v30
v_fma_f32 v118, v118, v30, v30
v_fma_f32 v119, v119, v30, v30
v_mfma_f32_32x32x16_bf16 v[44:59], a[108:111], v[88:91], v[44:59]
ds_read_b128 v[80:83], v41 offset:50176
s_waitcnt lgkmcnt(2)
s_add_u32 m0, s58, 2048
s_add_u32 s101, s96, 430080
buffer_load_dwordx4 v244, s[24:27], s101 offen offset:0  lds
buffer_load_dwordx4 v245, s[24:27], s101 offen offset:1024  lds
v_rcp_f32 v116, v116
v_rcp_f32 v117, v117
v_rcp_f32 v118, v118
v_mfma_f32_32x32x16_bf16 v[44:59], a[112:115], v[92:95], v[44:59]
ds_read_b128 v[84:87], v41 offset:51200
v_rcp_f32 v119, v119
v_mul_f32 v116, v116, v68
v_mfma_f32_32x32x16_bf16 v[44:59], a[116:119], v[96:99], v[44:59]
ds_read_b128 v[88:91], v41 offset:52224
v_mul_f32 v117, v117, v69
v_mul_f32 v118, v118, v70
v_mul_f32 v119, v119, v71
v_mfma_f32_32x32x16_bf16 v[44:59], a[120:123], v[100:103], v[44:59]
ds_read_b128 v[92:95], v41 offset:53248
v_cvt_pk_bf16_f32 v128, v116, v117
v_cvt_pk_bf16_f32 v129, v118, v119
v_fma_f32 v72, v28, v20, v72
v_mfma_f32_32x32x16_bf16 v[44:59], a[124:127], v[104:107], v[44:59]
ds_read_b128 v[96:99], v41 offset:54272
s_waitcnt vmcnt(7)
ds_read_b64_tr_b16 v[192:193], v2 offset:4096
ds_read_b64_tr_b16 v[194:195], v2 offset:4608
v_fma_f32 v73, v28, v21, v73
v_fma_f32 v74, v28, v22, v74
v_fma_f32 v75, v28, v23, v75
s_waitcnt lgkmcnt(6)
v_mfma_f32_32x32x16_bf16 v[44:59], a[128:131], v[76:79], v[44:59]
ds_read_b128 v[100:103], v41 offset:55296
ds_read_b64_tr_b16 v[196:197], v3 offset:4096
ds_read_b64_tr_b16 v[198:199], v3 offset:4608
v_mul_f32 v120, v29, v72
v_mul_f32 v121, v29, v73
v_mfma_f32_32x32x16_bf16 v[44:59], a[132:135], v[80:83], v[44:59]
ds_read_b128 v[104:107], v41 offset:56320
v_mul_f32 v122, v29, v74
v_mul_f32 v123, v29, v75
v_exp_f32 v120, v120
s_waitcnt lgkmcnt(8)
v_mfma_f32_32x32x16_bf16 v[44:59], a[136:139], v[84:87], v[44:59]
s_barrier
ds_read_b128 v[24:27], v42 offset:1024
ds_read_b128 v[76:79], v40 offset:0
s_waitcnt lgkmcnt(3)
s_add_u32 m0, s58, 4096
s_add_u32 s101, s96, 450560
buffer_load_dwordx4 v244, s[24:27], s101 offen offset:0  lds
buffer_load_dwordx4 v245, s[24:27], s101 offen offset:1024  lds
v_exp_f32 v121, v121
v_exp_f32 v122, v122
v_exp_f32 v123, v123
v_mfma_f32_32x32x16_bf16 v[44:59], a[140:143], v[88:91], v[44:59]
ds_read_b128 v[80:83], v40 offset:1024
v_fma_f32 v120, v120, v30, v30
v_fma_f32 v121, v121, v30, v30
v_fma_f32 v122, v122, v30, v30
v_mfma_f32_32x32x16_bf16 v[44:59], a[144:147], v[92:95], v[44:59]
ds_read_b128 v[84:87], v40 offset:2048
v_fma_f32 v123, v123, v30, v30
v_rcp_f32 v120, v120
v_mfma_f32_32x32x16_bf16 v[44:59], a[148:151], v[96:99], v[44:59]
ds_read_b128 v[88:91], v40 offset:3072
s_waitcnt vmcnt(7)
ds_read_b64_tr_b16 v[200:201], v2 offset:6144
ds_read_b64_tr_b16 v[202:203], v2 offset:6656
v_rcp_f32 v121, v121
v_rcp_f32 v122, v122
v_rcp_f32 v123, v123
s_waitcnt lgkmcnt(7)
v_mfma_f32_32x32x16_bf16 v[44:59], a[152:155], v[100:103], v[44:59]
ds_read_b128 v[92:95], v40 offset:4096
ds_read_b64_tr_b16 v[204:205], v3 offset:6144
ds_read_b64_tr_b16 v[206:207], v3 offset:6656
v_mul_f32 v120, v120, v72
v_mul_f32 v121, v121, v73
v_mul_f32 v122, v122, v74
v_mfma_f32_32x32x16_bf16 v[44:59], a[156:159], v[104:107], v[44:59]
ds_read_b128 v[96:99], v40 offset:5120
v_mul_f32 v123, v123, v75
v_cvt_pk_bf16_f32 v130, v120, v121
v_cvt_pk_bf16_f32 v131, v122, v123
buffer_store_dwordx4 v[128:131], v39, s[32:35], s47 offen offset:512
s_waitcnt lgkmcnt(8)
v_mfma_f32_32x32x16_bf16 v[60:75], a[0:3], v[76:79], 0
ds_read_b128 v[100:103], v40 offset:6144
s_waitcnt lgkmcnt(2)
s_add_u32 m0, s58, 6144
s_add_u32 s101, s96, 471040
buffer_load_dwordx4 v244, s[24:27], s101 offen offset:0  lds
buffer_load_dwordx4 v245, s[24:27], s101 offen offset:1024  lds
v_mfma_f32_32x32x16_bf16 v[60:75], a[4:7], v[80:83], v[60:75]
ds_read_b128 v[104:107], v40 offset:7168
v_mfma_f32_32x32x16_bf16 v[60:75], a[8:11], v[84:87], v[60:75]
ds_read_b128 v[76:79], v40 offset:8192
v_fma_f32 v44, v24, v8, v44
v_fma_f32 v45, v24, v9, v45
v_fma_f32 v46, v24, v10, v46
v_mfma_f32_32x32x16_bf16 v[60:75], a[12:15], v[88:91], v[60:75]
ds_read_b128 v[80:83], v40 offset:9216
v_fma_f32 v47, v24, v11, v47
v_mul_f32 v108, v25, v44
v_mul_f32 v109, v25, v45
s_waitcnt lgkmcnt(4)
v_mfma_f32_32x32x16_bf16 v[60:75], a[16:19], v[92:95], v[60:75]
ds_read_b128 v[84:87], v40 offset:10240
s_waitcnt vmcnt(8)
ds_read_b64_tr_b16 v[208:209], v2 offset:0
ds_read_b64_tr_b16 v[210:211], v2 offset:512
v_mul_f32 v110, v25, v46
v_mul_f32 v111, v25, v47
v_mfma_f32_32x32x16_bf16 v[60:75], a[20:23], v[96:99], v[60:75]
ds_read_b128 v[88:91], v40 offset:11264
ds_read_b64_tr_b16 v[212:213], v3 offset:0
ds_read_b64_tr_b16 v[214:215], v3 offset:512
v_exp_f32 v108, v108
v_exp_f32 v109, v109
v_exp_f32 v110, v110
s_waitcnt lgkmcnt(8)
v_mfma_f32_32x32x16_bf16 v[60:75], a[24:27], v[100:103], v[60:75]
ds_read_b128 v[92:95], v40 offset:12288
v_exp_f32 v111, v111
v_fma_f32 v108, v108, v26, v26
v_fma_f32 v109, v109, v26, v26
v_mfma_f32_32x32x16_bf16 v[60:75], a[28:31], v[104:107], v[60:75]
ds_read_b128 v[96:99], v40 offset:13312
s_waitcnt lgkmcnt(2)
s_add_u32 m0, s58, 0
s_add_u32 s101, s96, 491520
buffer_load_dwordx4 v244, s[24:27], s101 offen offset:0  lds
buffer_load_dwordx4 v245, s[24:27], s101 offen offset:1024  lds
v_fma_f32 v110, v110, v26, v26
v_fma_f32 v111, v111, v26, v26
v_rcp_f32 v108, v108
v_mfma_f32_32x32x16_bf16 v[60:75], a[32:35], v[76:79], v[60:75]
ds_read_b128 v[100:103], v40 offset:14336
v_rcp_f32 v109, v109
v_rcp_f32 v110, v110
v_mfma_f32_32x32x16_bf16 v[60:75], a[36:39], v[80:83], v[60:75]
ds_read_b128 v[104:107], v40 offset:15360
v_rcp_f32 v111, v111
v_mul_f32 v108, v108, v44
v_mul_f32 v109, v109, v45
v_mfma_f32_32x32x16_bf16 v[60:75], a[40:43], v[84:87], v[60:75]
ds_read_b128 v[76:79], v40 offset:16384
s_waitcnt vmcnt(7)
ds_read_b64_tr_b16 v[216:217], v2 offset:2048
ds_read_b64_tr_b16 v[218:219], v2 offset:2560
v_mul_f32 v110, v110, v46
v_mul_f32 v111, v111, v47
v_cvt_pk_bf16_f32 v124, v108, v109
v_mfma_f32_32x32x16_bf16 v[60:75], a[44:47], v[88:91], v[60:75]
ds_read_b128 v[80:83], v40 offset:17408
ds_read_b64_tr_b16 v[220:221], v3 offset:2048
ds_read_b64_tr_b16 v[222:223], v3 offset:2560
v_cvt_pk_bf16_f32 v125, v110, v111
v_fma_f32 v48, v24, v12, v48
v_fma_f32 v49, v24, v13, v49
s_waitcnt lgkmcnt(8)
v_mfma_f32_32x32x16_bf16 v[60:75], a[48:51], v[92:95], v[60:75]
ds_read_b128 v[84:87], v40 offset:18432
s_waitcnt vmcnt(4)
s_mov_b64 exec, 1
s_cmp_eq_u32 s90, 0
s_cbranch_scc1 Lw_43
buffer_store_dword v253, v254, s[32:35], s59 offen offset:0
s_branch Lw_42
Lw_43:
buffer_wbl2 sc1
s_waitcnt vmcnt(0)
buffer_store_dword v253, v254, s[32:35], s59 offen offset:0 sc0 sc1
Lw_42:
s_mov_b64 exec, -1
v_fma_f32 v50, v24, v14, v50
v_fma_f32 v51, v24, v15, v51
v_mfma_f32_32x32x16_bf16 v[60:75], a[52:55], v[96:99], v[60:75]
ds_read_b128 v[88:91], v40 offset:19456
s_waitcnt lgkmcnt(2)
s_add_u32 m0, s58, 2048
s_add_u32 s101, s96, 512000
buffer_load_dwordx4 v244, s[24:27], s101 offen offset:0  lds
buffer_load_dwordx4 v245, s[24:27], s101 offen offset:1024  lds
v_mul_f32 v112, v25, v48
v_mul_f32 v113, v25, v49
v_mul_f32 v114, v25, v50
v_mfma_f32_32x32x16_bf16 v[60:75], a[56:59], v[100:103], v[60:75]
ds_read_b128 v[92:95], v40 offset:20480
v_mul_f32 v115, v25, v51
v_exp_f32 v112, v112
v_exp_f32 v113, v113
v_mfma_f32_32x32x16_bf16 v[60:75], a[60:63], v[104:107], v[60:75]
ds_read_b128 v[96:99], v40 offset:21504
v_exp_f32 v114, v114
v_exp_f32 v115, v115
v_fma_f32 v112, v112, v26, v26
v_mfma_f32_32x32x16_bf16 v[60:75], a[64:67], v[76:79], v[60:75]
ds_read_b128 v[100:103], v40 offset:22528
v_fma_f32 v113, v113, v26, v26
v_fma_f32 v114, v114, v26, v26
v_mfma_f32_32x32x16_bf16 v[60:75], a[68:71], v[80:83], v[60:75]
ds_read_b128 v[104:107], v40 offset:23552
ds_read_b64_tr_b16 v[224:225], v2 offset:4096
ds_read_b64_tr_b16 v[226:227], v2 offset:4608
v_fma_f32 v115, v115, v26, v26
v_rcp_f32 v112, v112
v_rcp_f32 v113, v113
s_waitcnt lgkmcnt(6)
v_mfma_f32_32x32x16_bf16 v[60:75], a[72:75], v[84:87], v[60:75]
ds_read_b128 v[76:79], v40 offset:24576
ds_read_b64_tr_b16 v[228:229], v3 offset:4096
ds_read_b64_tr_b16 v[230:231], v3 offset:4608
v_rcp_f32 v114, v114
v_rcp_f32 v115, v115
v_mul_f32 v112, v112, v48
v_mfma_f32_32x32x16_bf16 v[60:75], a[76:79], v[88:91], v[60:75]
ds_read_b128 v[80:83], v40 offset:25600
v_mul_f32 v113, v113, v49
v_mul_f32 v114, v114, v50
v_mul_f32 v115, v115, v51
s_waitcnt lgkmcnt(8)
v_mfma_f32_32x32x16_bf16 v[60:75], a[80:83], v[92:95], v[60:75]
ds_read_b128 v[84:87], v40 offset:26624
s_waitcnt lgkmcnt(2)
s_add_u32 m0, s58, 4096
s_add_u32 s101, s96, 532480
buffer_load_dwordx4 v244, s[24:27], s101 offen offset:0  lds
buffer_load_dwordx4 v245, s[24:27], s101 offen offset:1024  lds
v_cvt_pk_bf16_f32 v126, v112, v113
v_cvt_pk_bf16_f32 v127, v114, v115
v_mfma_f32_32x32x16_bf16 v[60:75], a[84:87], v[96:99], v[60:75]
ds_read_b128 v[88:91], v40 offset:27648
buffer_store_dwordx4 v[124:127], v38, s[32:35], s47 offen offset:1024
v_fma_f32 v52, v24, v16, v52
v_fma_f32 v53, v24, v17, v53
v_mfma_f32_32x32x16_bf16 v[60:75], a[88:91], v[100:103], v[60:75]
ds_read_b128 v[92:95], v40 offset:28672
v_fma_f32 v54, v24, v18, v54
v_fma_f32 v55, v24, v19, v55
v_mul_f32 v116, v25, v52
v_mfma_f32_32x32x16_bf16 v[60:75], a[92:95], v[104:107], v[60:75]
ds_read_b128 v[96:99], v40 offset:29696
v_mul_f32 v117, v25, v53
v_mul_f32 v118, v25, v54
v_mul_f32 v119, v25, v55
s_waitcnt lgkmcnt(4)
v_mfma_f32_32x32x16_bf16 v[60:75], a[96:99], v[76:79], v[60:75]
ds_read_b128 v[100:103], v40 offset:30720
v_exp_f32 v116, v116
v_exp_f32 v117, v117
v_mfma_f32_32x32x16_bf16 v[60:75], a[100:103], v[80:83], v[60:75]
ds_read_b128 v[104:107], v40 offset:31744
v_exp_f32 v118, v118
v_exp_f32 v119, v119
v_fma_f32 v116, v116, v26, v26
s_waitcnt lgkmcnt(4)
v_mfma_f32_32x32x16_bf16 v[60:75], a[104:107], v[84:87], v[60:75]
ds_read_b128 v[76:79], v40 offset:32768
v_fma_f32 v117, v117, v26, v26
v_fma_f32 v118, v118, v26, v26
v_fma_f32 v119, v119, v26, v26
v_mfma_f32_32x32x16_bf16 v[60:75], a[108:111], v[88:91], v[60:75]
ds_read_b128 v[80:83], v40 offset:33792
v_rcp_f32 v116, v116
v_rcp_f32 v117, v117
v_rcp_f32 v118, v118
s_waitcnt lgkmcnt(4)
v_mfma_f32_32x32x16_bf16 v[60:75], a[112:115], v[92:95], v[60:75]
ds_read_b128 v[84:87], v40 offset:34816
v_rcp_f32 v119, v119
v_mul_f32 v116, v116, v52
v_mfma_f32_32x32x16_bf16 v[60:75], a[116:119], v[96:99], v[60:75]
ds_read_b128 v[88:91], v40 offset:35840
v_mul_f32 v117, v117, v53
v_mul_f32 v118, v118, v54
v_mul_f32 v119, v119, v55
s_waitcnt lgkmcnt(4)
v_mfma_f32_32x32x16_bf16 v[60:75], a[120:123], v[100:103], v[60:75]
ds_read_b128 v[92:95], v40 offset:36864
buffer_load_dword v255, v254, s[32:35], s55 offen sc1
v_cvt_pk_bf16_f32 v128, v116, v117
v_cvt_pk_bf16_f32 v129, v118, v119
v_fma_f32 v56, v24, v20, v56
v_mfma_f32_32x32x16_bf16 v[60:75], a[124:127], v[104:107], v[60:75]
ds_read_b128 v[96:99], v40 offset:37888
v_fma_f32 v57, v24, v21, v57
v_fma_f32 v58, v24, v22, v58
v_fma_f32 v59, v24, v23, v59
s_waitcnt lgkmcnt(4)
v_mfma_f32_32x32x16_bf16 v[60:75], a[128:131], v[76:79], v[60:75]
ds_read_b128 v[100:103], v40 offset:38912
s_waitcnt vmcnt(8)
ds_read_b64_tr_b16 v[232:233], v2 offset:6144
ds_read_b64_tr_b16 v[234:235], v2 offset:6656
v_mul_f32 v120, v25, v56
v_mul_f32 v121, v25, v57
v_mfma_f32_32x32x16_bf16 v[60:75], a[132:135], v[80:83], v[60:75]
ds_read_b128 v[104:107], v40 offset:39936
ds_read_b64_tr_b16 v[236:237], v3 offset:6144
ds_read_b64_tr_b16 v[238:239], v3 offset:6656
v_mul_f32 v122, v25, v58
v_mul_f32 v123, v25, v59
v_exp_f32 v120, v120
s_waitcnt lgkmcnt(8)
v_mfma_f32_32x32x16_bf16 v[60:75], a[136:139], v[84:87], v[60:75]
ds_read_b128 v[28:31], v42 offset:1536
v_exp_f32 v121, v121
v_exp_f32 v122, v122
v_exp_f32 v123, v123
v_mfma_f32_32x32x16_bf16 v[60:75], a[140:143], v[88:91], v[60:75]
v_fma_f32 v120, v120, v26, v26
v_fma_f32 v121, v121, v26, v26
v_fma_f32 v122, v122, v26, v26
s_waitcnt lgkmcnt(7)
v_mfma_f32_32x32x16_bf16 v[60:75], a[144:147], v[92:95], v[60:75]
v_fma_f32 v123, v123, v26, v26
v_rcp_f32 v120, v120
v_mfma_f32_32x32x16_bf16 v[60:75], a[148:151], v[96:99], v[60:75]
v_rcp_f32 v121, v121
v_rcp_f32 v122, v122
v_rcp_f32 v123, v123
s_waitcnt lgkmcnt(3)
v_mfma_f32_32x32x16_bf16 v[60:75], a[152:155], v[100:103], v[60:75]
v_mul_f32 v120, v120, v56
v_mul_f32 v121, v121, v57
v_mul_f32 v122, v122, v58
v_mfma_f32_32x32x16_bf16 v[60:75], a[156:159], v[104:107], v[60:75]
v_mul_f32 v123, v123, v59
v_cvt_pk_bf16_f32 v130, v120, v121
v_cvt_pk_bf16_f32 v131, v122, v123
buffer_store_dwordx4 v[128:131], v39, s[32:35], s47 offen offset:1024
s_waitcnt vmcnt(1)
v_cmp_ne_u32 vcc, s7, v255
Lk_44:
s_and_b64 vcc, vcc, s[56:57]
s_cbranch_scc0 Lk_45
s_sub_u32 s91, s91, 1
s_cbranch_scc1 Lend
buffer_load_dword v255, v254, s[32:35], s55 offen sc1
s_waitcnt vmcnt(0)
s_waitcnt vmcnt(0)
v_cmp_ne_u32 vcc, s7, v255
s_nop 1
s_branch Lk_44
Lk_45:
s_cmp_lg_u32 s90, 0
s_cbranch_scc1 Lk_46
buffer_inv sc1
s_waitcnt vmcnt(0)
Lk_46:
s_waitcnt lgkmcnt(0)
s_nop 0
v_pk_fma_f32 v[60:61], v[8:9], v[28:29], v[60:61] op_sel_hi:[1,0,1]
s_add_u32 s46, s52, 0
buffer_load_dwordx4 a[24:27], v143, s[32:35], s46 offen sc1
v_pk_fma_f32 v[62:63], v[10:11], v[28:29], v[62:63] op_sel_hi:[1,0,1]
v_pk_mul_f32 v[108:109], v[60:61], v[28:29] op_sel:[0,1] op_sel_hi:[1,1]
v_pk_mul_f32 v[110:111], v[62:63], v[28:29] op_sel:[0,1] op_sel_hi:[1,1]
v_exp_f32 v108, v108
v_exp_f32 v109, v109
s_add_u32 s46, s52, 8704
buffer_load_dwordx4 a[28:31], v143, s[32:35], s46 offen sc1
v_exp_f32 v110, v110
v_exp_f32 v111, v111
v_pk_fma_f32 v[108:109], v[108:109], v[30:31], v[30:31] op_sel_hi:[1,0,0]
v_pk_fma_f32 v[110:111], v[110:111], v[30:31], v[30:31] op_sel_hi:[1,0,0]
v_rcp_f32 v108, v108
v_rcp_f32 v109, v109
s_add_u32 s46, s52, 17408
buffer_load_dwordx4 a[32:35], v143, s[32:35], s46 offen sc1
v_rcp_f32 v110, v110
v_rcp_f32 v111, v111
v_pk_mul_f32 v[108:109], v[108:109], v[60:61]
v_pk_mul_f32 v[110:111], v[110:111], v[62:63]
v_cvt_pk_bf16_f32 v124, v108, v109
s_add_u32 s46, s52, 26112
buffer_load_dwordx4 a[36:39], v143, s[32:35], s46 offen sc1
v_cvt_pk_bf16_f32 v125, v110, v111
v_pk_fma_f32 v[64:65], v[12:13], v[28:29], v[64:65] op_sel_hi:[1,0,1]
v_pk_fma_f32 v[66:67], v[14:15], v[28:29], v[66:67] op_sel_hi:[1,0,1]
v_pk_mul_f32 v[112:113], v[64:65], v[28:29] op_sel:[0,1] op_sel_hi:[1,1]
v_pk_mul_f32 v[114:115], v[66:67], v[28:29] op_sel:[0,1] op_sel_hi:[1,1]
v_exp_f32 v112, v112
s_add_u32 s46, s52, 34816
buffer_load_dwordx4 a[40:43], v143, s[32:35], s46 offen sc1
v_exp_f32 v113, v113
v_exp_f32 v114, v114
v_exp_f32 v115, v115
v_pk_fma_f32 v[112:113], v[112:113], v[30:31], v[30:31] op_sel_hi:[1,0,0]
v_pk_fma_f32 v[114:115], v[114:115], v[30:31], v[30:31] op_sel_hi:[1,0,0]
s_add_u32 s46, s52, 43520
buffer_load_dwordx4 a[44:47], v143, s[32:35], s46 offen sc1
v_rcp_f32 v112, v112
v_rcp_f32 v113, v113
v_rcp_f32 v114, v114
v_rcp_f32 v115, v115
v_pk_mul_f32 v[112:113], v[112:113], v[64:65]
v_pk_mul_f32 v[114:115], v[114:115], v[66:67]
s_waitcnt vmcnt(6)
s_mov_b64 exec, 1
s_cmp_eq_u32 s90, 0
s_cbranch_scc1 Lw_48
buffer_store_dword v253, v254, s[32:35], s59 offen offset:512
s_branch Lw_47
Lw_48:
buffer_wbl2 sc1
s_waitcnt vmcnt(0)
buffer_store_dword v253, v254, s[32:35], s59 offen offset:512 sc0 sc1
Lw_47:
s_mov_b64 exec, -1
v_cvt_pk_bf16_f32 v126, v112, v113
v_cvt_pk_bf16_f32 v127, v114, v115
buffer_store_dwordx4 v[124:127], v38, s[32:35], s47 offen offset:1536
v_pk_fma_f32 v[68:69], v[16:17], v[28:29], v[68:69] op_sel_hi:[1,0,1]
v_pk_fma_f32 v[70:71], v[18:19], v[28:29], v[70:71] op_sel_hi:[1,0,1]
s_add_u32 s46, s52, 52224
buffer_load_dwordx4 a[48:51], v143, s[32:35], s46 offen sc1
v_pk_mul_f32 v[116:117], v[68:69], v[28:29] op_sel:[0,1] op_sel_hi:[1,1]
v_pk_mul_f32 v[118:119], v[70:71], v[28:29] op_sel:[0,1] op_sel_hi:[1,1]
v_exp_f32 v116, v116
v_exp_f32 v117, v117
v_exp_f32 v118, v118
v_exp_f32 v119, v119
s_add_u32 s46, s52, 60928
buffer_load_dwordx4 a[52:55], v143, s[32:35], s46 offen sc1
v_pk_fma_f32 v[116:117], v[116:117], v[30:31], v[30:31] op_sel_hi:[1,0,0]
v_pk_fma_f32 v[118:119], v[118:119], v[30:31], v[30:31] op_sel_hi:[1,0,0]
v_rcp_f32 v116, v116
v_rcp_f32 v117, v117
v_rcp_f32 v118, v118
s_add_u32 s46, s52, 69632
buffer_load_dwordx4 a[56:59], v143, s[32:35], s46 offen sc1
v_rcp_f32 v119, v119
v_pk_mul_f32 v[116:117], v[116:117], v[68:69]
v_pk_mul_f32 v[118:119], v[118:119], v[70:71]
v_cvt_pk_bf16_f32 v128, v116, v117
v_cvt_pk_bf16_f32 v129, v118, v119
v_pk_fma_f32 v[72:73], v[20:21], v[28:29], v[72:73] op_sel_hi:[1,0,1]
s_add_u32 s46, s52, 78336
buffer_load_dwordx4 a[60:63], v143, s[32:35], s46 offen sc1
v_pk_fma_f32 v[74:75], v[22:23], v[28:29], v[74:75] op_sel_hi:[1,0,1]
v_pk_mul_f32 v[120:121], v[72:73], v[28:29] op_sel:[0,1] op_sel_hi:[1,1]
v_pk_mul_f32 v[122:123], v[74:75], v[28:29] op_sel:[0,1] op_sel_hi:[1,1]
v_exp_f32 v120, v120
v_exp_f32 v121, v121
s_add_u32 s46, s52, 87040
buffer_load_dwordx4 a[64:67], v143, s[32:35], s46 offen sc1
v_exp_f32 v122, v122
v_exp_f32 v123, v123
v_pk_fma_f32 v[120:121], v[120:121], v[30:31], v[30:31] op_sel_hi:[1,0,0]
v_pk_fma_f32 v[122:123], v[122:123], v[30:31], v[30:31] op_sel_hi:[1,0,0]
v_rcp_f32 v120, v120
v_rcp_f32 v121, v121
s_add_u32 s46, s52, 95744
buffer_load_dwordx4 a[68:71], v143, s[32:35], s46 offen sc1
v_rcp_f32 v122, v122
v_rcp_f32 v123, v123
v_pk_mul_f32 v[120:121], v[120:121], v[72:73]
v_pk_mul_f32 v[122:123], v[122:123], v[74:75]
v_cvt_pk_bf16_f32 v130, v120, v121
v_cvt_pk_bf16_f32 v131, v122, v123
buffer_store_dwordx4 v[128:131], v39, s[32:35], s47 offen offset:1536
ds_read_b64_tr_b16 a[0:1], v2 offset:0
ds_read_b64_tr_b16 a[2:3], v2 offset:512
ds_read_b64_tr_b16 a[4:5], v3 offset:0
ds_read_b64_tr_b16 a[6:7], v3 offset:512
ds_read_b64_tr_b16 a[8:9], v2 offset:2048
ds_read_b64_tr_b16 a[10:11], v2 offset:2560
ds_read_b64_tr_b16 a[12:13], v3 offset:2048
ds_read_b64_tr_b16 a[14:15], v3 offset:2560
ds_read_b64_tr_b16 a[16:17], v2 offset:4096
ds_read_b64_tr_b16 a[18:19], v2 offset:4608
ds_read_b64_tr_b16 a[20:21], v3 offset:4096
ds_read_b64_tr_b16 a[22:23], v3 offset:4608
v_and_b32 v112, 31, v0
v_lshrrev_b32 v113, 5, v0
v_mul_u32_u24 v114, 1280, v112
v_lshl_add_u32 v105, v113, 4, v114
v_lshlrev_b32 v112, 4, v0
v_add_u32 v112, 40960, v112
s_mul_i32 s3, s6, 6144
v_add_u32 v104, s3, v112
s_xor_b32 s3, s6, 1
s_mul_i32 s3, s3, 6144
s_add_u32 s3, s3, 0
v_add_u32 v106, s3, v112
s_xor_b32 s3, s6, 2
s_mul_i32 s3, s3, 6144
s_add_u32 s3, s3, 2048
v_add_u32 v107, s3, v112
s_xor_b32 s3, s6, 3
s_mul_i32 s3, s3, 6144
s_add_u32 s3, s3, 4096
v_add_u32 v108, s3, v112
s_lshl_b32 s43, s4, 8
s_add_u32 s43, s43, s40
s_mul_i32 s43, s43, 1280
s_lshl_b32 s45, s97, 2
s_add_u32 s45, s45, s6
s_mul_i32 s47, s45, 8704
s_lshl_b32 s45, s45, 5
s_add_u32 s43, s43, s45
s_mul_i32 s45, s41, 1280
s_add_u32 s44, s43, s45
s_add_u32 s45, s44, s45
s_lshl_b32 s40, s40, 4
s_add_u32 s47, s47, s40
s_add_u32 s47, s47, 348416
s_add_u32 s50, s47, s42
s_add_u32 s51, s50, s42
s_add_u32 s41, s55, 512
s_cmp_eq_u32 s98, 2
s_cselect_b32 s43, 2130706432, s43
s_cselect_b32 s47, 2130706432, s47
s_cselect_b32 s41, 1739008, s41
s_cselect_b64 s[56:57], s[48:49], 0
s_mov_b32 s55, 1738752
buffer_load_dwordx4 v[68:71], v143, s[32:35], s47 offen sc1
s_waitcnt vmcnt(14)
v_mfma_f32_32x32x16_bf16 v[4:19], a[160:163], a[24:27], 0
buffer_load_dword v255, v254, s[32:35], s55 offen sc1
s_add_u32 s46, s52, 104448
buffer_load_dwordx4 a[72:75], v143, s[32:35], s46 offen sc1
v_mfma_f32_32x32x16_bf16 v[20:35], a[164:167], a[24:27], 0
s_add_u32 s46, s52, 113152
buffer_load_dwordx4 a[76:79], v143, s[32:35], s46 offen sc1
s_waitcnt vmcnt(16)
v_mfma_f32_32x32x16_bf16 v[4:19], a[168:171], a[28:31], v[4:19]
s_add_u32 s46, s52, 121856
s_sub_u32 s46, s46, s93
buffer_load_dwordx4 a[80:83], v143, s[32:35], s46 offen sc1
v_mfma_f32_32x32x16_bf16 v[20:35], a[172:175], a[28:31], v[20:35]
s_add_u32 s46, s52, 130560
s_sub_u32 s46, s46, s93
buffer_load_dwordx4 a[84:87], v143, s[32:35], s46 offen sc1
s_waitcnt vmcnt(17)
v_mfma_f32_32x32x16_bf16 v[4:19], a[176:179], a[32:35], v[4:19]
s_add_u32 s46, s52, 139264
s_sub_u32 s46, s46, s93
buffer_load_dwordx4 a[88:91], v143, s[32:35], s46 offen sc1
v_mfma_f32_32x32x16_bf16 v[20:35], a[180:183], a[32:35], v[20:35]
s_add_u32 s46, s52, 147968
s_sub_u32 s46, s46, s93
buffer_load_dwordx4 a[92:95], v143, s[32:35], s46 offen sc1
s_waitcnt vmcnt(18)
v_mfma_f32_32x32x16_bf16 v[4:19], a[184:187], a[36:39], v[4:19]
s_waitcnt vmcnt(8)
s_mov_b64 exec, 1
s_cmp_eq_u32 s90, 0
s_cbranch_scc1 Lw_50
buffer_store_dword v253, v254, s[32:35], s59 offen offset:1024
s_branch Lw_49
Lw_50:
buffer_wbl2 sc1
s_waitcnt vmcnt(0)
buffer_store_dword v253, v254, s[32:35], s59 offen offset:1024 sc0 sc1
Lw_49:
s_mov_b64 exec, -1
s_add_u32 s46, s52, 156672
s_sub_u32 s46, s46, s93
buffer_load_dwordx4 a[96:99], v143, s[32:35], s46 offen sc1
v_mfma_f32_32x32x16_bf16 v[20:35], a[188:191], a[36:39], v[20:35]
v_mfma_f32_32x32x16_bf16 v[4:19], a[192:195], a[40:43], v[4:19]
s_add_u32 s46, s52, 165376
s_sub_u32 s46, s46, s93
buffer_load_dwordx4 a[100:103], v143, s[32:35], s46 offen sc1
v_mfma_f32_32x32x16_bf16 v[20:35], a[196:199], a[40:43], v[20:35]
v_mfma_f32_32x32x16_bf16 v[4:19], a[200:203], a[44:47], v[4:19]
s_add_u32 s46, s52, 174080
s_sub_u32 s46, s46, s93
buffer_load_dwordx4 a[104:107], v143, s[32:35], s46 offen sc1
v_mfma_f32_32x32x16_bf16 v[20:35], a[204:207], a[44:47], v[20:35]
v_mfma_f32_32x32x16_bf16 v[4:19], a[208:211], a[48:51], v[4:19]
s_add_u32 s46, s52, 182784
s_sub_u32 s46, s46, s93
buffer_load_dwordx4 a[108:111], v143, s[32:35], s46 offen sc1
v_mfma_f32_32x32x16_bf16 v[20:35], a[212:215], a[48:51], v[20:35]
v_mfma_f32_32x32x16_bf16 v[4:19], a[216:219], a[52:55], v[4:19]
s_add_u32 s46, s52, 191488
s_sub_u32 s46, s46, s93
buffer_load_dwordx4 a[112:115], v143, s[32:35], s46 offen sc1
v_mfma_f32_32x32x16_bf16 v[20:35], a[220:223], a[52:55], v[20:35]
v_mfma_f32_32x32x16_bf16 v[4:19], a[224:227], a[56:59], v[4:19]
s_add_u32 s46, s52, 200192
s_sub_u32 s46, s46, s93
buffer_load_dwordx4 a[116:119], v143, s[32:35], s46 offen sc1
v_mfma_f32_32x32x16_bf16 v[20:35], a[228:231], a[56:59], v[20:35]
v_mfma_f32_32x32x16_bf16 v[4:19], a[232:235], a[60:63], v[4:19]
s_add_u32 s46, s52, 208896
s_sub_u32 s46, s46, s93
buffer_load_dwordx4 a[120:123], v143, s[32:35], s46 offen sc1
v_mfma_f32_32x32x16_bf16 v[20:35], a[236:239], a[60:63], v[20:35]
v_mfma_f32_32x32x16_bf16 v[4:19], a[240:243], a[64:67], v[4:19]
s_add_u32 s46, s52, 217600
s_sub_u32 s46, s46, s93
buffer_load_dwordx4 a[124:127], v143, s[32:35], s46 offen sc1
v_mfma_f32_32x32x16_bf16 v[20:35], a[244:247], a[64:67], v[20:35]
v_mfma_f32_32x32x16_bf16 v[4:19], a[248:251], a[68:71], v[4:19]
s_add_u32 s46, s52, 226304
s_sub_u32 s46, s46, s93
buffer_load_dwordx4 a[128:131], v143, s[32:35], s46 offen sc1
v_mfma_f32_32x32x16_bf16 v[20:35], a[252:255], a[68:71], v[20:35]
s_waitcnt vmcnt(14)
v_mfma_f32_32x32x16_bf16 v[4:19], v[144:147], a[72:75], v[4:19]
v_cmp_ne_u32 vcc, s7, v255
Lk_51:
s_and_b64 vcc, vcc, s[56:57]
s_cbranch_scc0 Lk_52
s_sub_u32 s91, s91, 1
s_cbranch_scc1 Lend
buffer_load_dword v255, v254, s[32:35], s55 offen sc1
s_waitcnt vmcnt(0)
s_waitcnt vmcnt(0)
v_cmp_ne_u32 vcc, s7, v255
s_nop 1
s_branch Lk_51
Lk_52:
s_cmp_lg_u32 s90, 0
s_cbranch_scc1 Lk_53
buffer_inv sc1
s_waitcnt vmcnt(0)
Lk_53:
buffer_load_dwordx4 v[72:75], v143, s[32:35], s50 offen sc1
s_add_u32 s46, s53, 0
buffer_load_dwordx4 a[132:135], v143, s[32:35], s46 offen sc1
v_mfma_f32_32x32x16_bf16 v[20:35], v[148:151], a[72:75], v[20:35]
s_waitcnt vmcnt(15)
v_mfma_f32_32x32x16_bf16 v[4:19], v[152:155], a[76:79], v[4:19]
s_add_u32 s46, s53, 8704
buffer_load_dwordx4 a[136:139], v143, s[32:35], s46 offen sc1
v_mfma_f32_32x32x16_bf16 v[20:35], v[156:159], a[76:79], v[20:35]
s_waitcnt vmcnt(15)
v_mfma_f32_32x32x16_bf16 v[4:19], v[160:163], a[80:83], v[4:19]
s_add_u32 s46, s53, 17408
buffer_load_dwordx4 a[140:143], v143, s[32:35], s46 offen sc1
v_mfma_f32_32x32x16_bf16 v[20:35], v[164:167], a[80:83], v[20:35]
s_waitcnt vmcnt(15)
v_mfma_f32_32x32x16_bf16 v[4:19], v[168:171], a[84:87], v[4:19]
s_add_u32 s46, s53, 26112
buffer_load_dwordx4 a[144:147], v143, s[32:35], s46 offen sc1
v_mfma_f32_32x32x16_bf16 v[20:35], v[172:175], a[84:87], v[20:35]
s_waitcnt vmcnt(15)
v_mfma_f32_32x32x16_bf16 v[4:19], v[176:179], a[88:91], v[4:19]
s_add_u32 s46, s53, 34816
buffer_load_dwordx4 a[148:151], v143, s[32:35], s46 offen sc1
v_mfma_f32_32x32x16_bf16 v[20:35], v[180:183], a[88:91], v[20:35]
s_waitcnt vmcnt(15)
v_mfma_f32_32x32x16_bf16 v[4:19], v[184:187], a[92:95], v[4:19]
s_add_u32 s46, s53, 43520
buffer_load_dwordx4 a[152:155], v143, s[32:35], s46 offen sc1
v_mfma_f32_32x32x16_bf16 v[20:35], v[188:191], a[92:95], v[20:35]
s_waitcnt vmcnt(15)
v_mfma_f32_32x32x16_bf16 v[4:19], v[192:195], a[96:99], v[4:19]
s_add_u32 s46, s53, 52224
buffer_load_dwordx4 a[156:159], v143, s[32:35], s46 offen sc1
v_mfma_f32_32x32x16_bf16 v[20:35], v[196:199], a[96:99], v[20:35]
s_waitcnt vmcnt(15)
v_mfma_f32_32x32x16_bf16 v[4:19], v[200:203], a[100:103], v[4:19]
s_add_u32 s46, s53, 60928
buffer_load_dwordx4 a[24:27], v143, s[32:35], s46 offen sc1
v_mfma_f32_32x32x16_bf16 v[20:35], v[204:207], a[100:103], v[20:35]
s_waitcnt vmcnt(15)
v_mfma_f32_32x32x16_bf16 v[4:19], v[208:211], a[104:107], v[4:19]
s_add_u32 s46, s53, 69632
buffer_load_dwordx4 a[28:31], v143, s[32:35], s46 offen sc1
v_mfma_f32_32x32x16_bf16 v[20:35], v[212:215], a[104:107], v[20:35]
s_waitcnt vmcnt(15)
v_mfma_f32_32x32x16_bf16 v[4:19], v[216:219], a[108:111], v[4:19]
s_add_u32 s46, s53, 78336
buffer_load_dwordx4 a[32:35], v143, s[32:35], s46 offen sc1
v_mfma_f32_32x32x16_bf16 v[20:35], v[220:223], a[108:111], v[20:35]
s_waitcnt vmcnt(15)
v_mfma_f32_32x32x16_bf16 v[4:19], v[224:227], a[112:115], v[4:19]
s_add_u32 s46, s53, 87040
buffer_load_dwordx4 a[36:39], v143, s[32:35], s46 offen sc1
v_mfma_f32_32x32x16_bf16 v[20:35], v[228:231], a[112:115], v[20:35]
s_waitcnt vmcnt(15)
v_mfma_f32_32x32x16_bf16 v[4:19], v[232:235], a[116:119], v[4:19]
s_add_u32 s46, s53, 95744
buffer_load_dwordx4 a[40:43], v143, s[32:35], s46 offen sc1
v_mfma_f32_32x32x16_bf16 v[20:35], v[236:239], a[116:119], v[20:35]
s_waitcnt vmcnt(15) lgkmcnt(10)
v_mfma_f32_32x32x16_bf16 v[4:19], a[0:3], a[120:123], v[4:19]
buffer_load_dword v255, v254, s[32:35], s41 offen sc1
s_add_u32 s46, s53, 104448
buffer_load_dwordx4 a[44:47], v143, s[32:35], s46 offen sc1
s_waitcnt lgkmcnt(8)
v_mfma_f32_32x32x16_bf16 v[20:35], a[4:7], a[120:123], v[20:35]
s_waitcnt vmcnt(16) lgkmcnt(6)
v_mfma_f32_32x32x16_bf16 v[4:19], a[8:11], a[124:127], v[4:19]
s_add_u32 s46, s53, 113152
buffer_load_dwordx4 a[48:51], v143, s[32:35], s46 offen sc1
s_waitcnt lgkmcnt(4)
v_mfma_f32_32x32x16_bf16 v[20:35], a[12:15], a[124:127], v[20:35]
s_waitcnt vmcnt(16) lgkmcnt(2)
v_mfma_f32_32x32x16_bf16 v[4:19], a[16:19], a[128:131], v[4:19]
s_add_u32 s46, s53, 121856
s_sub_u32 s46, s46, s93
buffer_load_dwordx4 a[52:55], v143, s[32:35], s46 offen sc1
s_waitcnt lgkmcnt(0)
v_mfma_f32_32x32x16_bf16 v[20:35], a[20:23], a[128:131], v[20:35]
s_waitcnt vmcnt(15)
v_mfma_f32_32x32x16_bf16 v[36:51], a[160:163], a[132:135], 0
s_add_u32 s46, s53, 130560
s_sub_u32 s46, s46, s93
buffer_load_dwordx4 a[56:59], v143, s[32:35], s46 offen sc1
v_mfma_f32_32x32x16_bf16 v[52:67], a[164:167], a[132:135], 0
s_waitcnt vmcnt(15)
v_mfma_f32_32x32x16_bf16 v[36:51], a[168:171], a[136:139], v[36:51]
ds_write_b128 v106, v[12:15] offset:0
s_add_u32 s46, s53, 139264
s_sub_u32 s46, s46, s93
buffer_load_dwordx4 a[60:63], v143, s[32:35], s46 offen sc1
v_mfma_f32_32x32x16_bf16 v[52:67], a[172:175], a[136:139], v[52:67]
ds_write_b128 v106, v[16:19] offset:1024
s_waitcnt vmcnt(15)
v_mfma_f32_32x32x16_bf16 v[36:51], a[176:179], a[140:143], v[36:51]
ds_write_b128 v107, v[20:23] offset:0
s_add_u32 s46, s53, 147968
s_sub_u32 s46, s46, s93
buffer_load_dwordx4 a[64:67], v143, s[32:35], s46 offen sc1
v_mfma_f32_32x32x16_bf16 v[52:67], a[180:183], a[140:143], v[52:67]
ds_write_b128 v107, v[24:27] offset:1024
s_waitcnt vmcnt(15)
v_mfma_f32_32x32x16_bf16 v[36:51], a[184:187], a[144:147], v[36:51]
ds_write_b128 v108, v[28:31] offset:0
s_add_u32 s46, s53, 156672
s_sub_u32 s46, s46, s93
buffer_load_dwordx4 a[68:71], v143, s[32:35], s46 offen sc1
v_mfma_f32_32x32x16_bf16 v[52:67], a[188:191], a[144:147], v[52:67]
ds_write_b128 v108, v[32:35] offset:1024
s_waitcnt vmcnt(15)
v_mfma_f32_32x32x16_bf16 v[36:51], a[192:195], a[148:151], v[36:51]
v_lshlrev_b32 v112, 16, v68
v_and_b32 v113, 0xffff0000, v68
s_add_u32 s46, s53, 165376
s_sub_u32 s46, s46, s93
buffer_load_dwordx4 a[72:75], v143, s[32:35], s46 offen sc1
v_mfma_f32_32x32x16_bf16 v[52:67], a[196:199], a[148:151], v[52:67]
v_add_f32 v4, v4, v112
v_add_f32 v5, v5, v113
s_waitcnt vmcnt(15)
v_mfma_f32_32x32x16_bf16 v[36:51], a[200:203], a[152:155], v[36:51]
v_lshlrev_b32 v112, 16, v69
v_and_b32 v113, 0xffff0000, v69
s_add_u32 s46, s53, 174080
s_sub_u32 s46, s46, s93
buffer_load_dwordx4 a[76:79], v143, s[32:35], s46 offen sc1
v_mfma_f32_32x32x16_bf16 v[52:67], a[204:207], a[152:155], v[52:67]
v_add_f32 v6, v6, v112
v_add_f32 v7, v7, v113
s_waitcnt vmcnt(15)
v_mfma_f32_32x32x16_bf16 v[36:51], a[208:211], a[156:159], v[36:51]
v_lshlrev_b32 v112, 16, v70
v_and_b32 v113, 0xffff0000, v70
s_add_u32 s46, s53, 182784
s_sub_u32 s46, s46, s93
buffer_load_dwordx4 a[80:83], v143, s[32:35], s46 offen sc1
v_mfma_f32_32x32x16_bf16 v[52:67], a[212:215], a[156:159], v[52:67]
v_add_f32 v8, v8, v112
v_add_f32 v9, v9, v113
s_waitcnt vmcnt(15)
v_mfma_f32_32x32x16_bf16 v[36:51], a[216:219], a[24:27], v[36:51]
v_lshlrev_b32 v112, 16, v71
v_and_b32 v113, 0xffff0000, v71
s_add_u32 s46, s53, 191488
s_sub_u32 s46, s46, s93
buffer_load_dwordx4 a[84:87], v143, s[32:35], s46 offen sc1
v_mfma_f32_32x32x16_bf16 v[52:67], a[220:223], a[24:27], v[52:67]
v_add_f32 v10, v10, v112
v_add_f32 v11, v11, v113
s_waitcnt vmcnt(15)
v_mfma_f32_32x32x16_bf16 v[36:51], a[224:227], a[28:31], v[36:51]
s_waitcnt lgkmcnt(0)
s_barrier
s_add_u32 s46, s53, 200192
s_sub_u32 s46, s46, s93
buffer_load_dwordx4 a[88:91], v143, s[32:35], s46 offen sc1
v_mfma_f32_32x32x16_bf16 v[52:67], a[228:231], a[28:31], v[52:67]
ds_read_b128 v[80:83], v104 offset:0
s_waitcnt vmcnt(15)
v_mfma_f32_32x32x16_bf16 v[36:51], a[232:235], a[32:35], v[36:51]
ds_read_b128 v[84:87], v104 offset:1024
s_add_u32 s46, s53, 208896
s_sub_u32 s46, s46, s93
buffer_load_dwordx4 a[92:95], v143, s[32:35], s46 offen sc1
v_mfma_f32_32x32x16_bf16 v[52:67], a[236:239], a[32:35], v[52:67]
ds_read_b128 v[88:91], v104 offset:2048
s_waitcnt vmcnt(15)
v_mfma_f32_32x32x16_bf16 v[36:51], a[240:243], a[36:39], v[36:51]
ds_read_b128 v[92:95], v104 offset:3072
s_add_u32 s46, s53, 217600
s_sub_u32 s46, s46, s93
buffer_load_dwordx4 a[96:99], v143, s[32:35], s46 offen sc1
v_mfma_f32_32x32x16_bf16 v[52:67], a[244:247], a[36:39], v[52:67]
ds_read_b128 v[96:99], v104 offset:4096
s_waitcnt vmcnt(15)
v_mfma_f32_32x32x16_bf16 v[36:51], a[248:251], a[40:43], v[36:51]
ds_read_b128 v[100:103], v104 offset:5120
s_add_u32 s46, s53, 226304
s_sub_u32 s46, s46, s93
buffer_load_dwordx4 a[100:103], v143, s[32:35], s46 offen sc1
v_mfma_f32_32x32x16_bf16 v[52:67], a[252:255], a[40:43], v[52:67]
s_waitcnt lgkmcnt(5)
v_add_f32 v4, v4, v80
s_waitcnt vmcnt(14)
v_mfma_f32_32x32x16_bf16 v[36:51], v[144:147], a[44:47], v[36:51]
v_add_f32 v5, v5, v81
v_cmp_ne_u32 vcc, s7, v255
Lk_54:
s_and_b64 vcc, vcc, s[48:49]
s_cbranch_scc0 Lk_55
s_sub_u32 s91, s91, 1
s_cbranch_scc1 Lend
buffer_load_dword v255, v254, s[32:35], s41 offen sc1
s_waitcnt vmcnt(0)
s_waitcnt vmcnt(0)
v_cmp_ne_u32 vcc, s7, v255
s_nop 1
s_branch Lk_54
Lk_55:
s_cmp_lg_u32 s90, 0
s_cbranch_scc1 Lk_56
buffer_inv sc1
s_waitcnt vmcnt(0)
Lk_56:
buffer_load_dwordx4 v[76:79], v143, s[32:35], s51 offen sc1
s_add_u32 s46, s54, 0
buffer_load_dwordx4 a[104:107], v143, s[32:35], s46 offen sc1
v_mfma_f32_32x32x16_bf16 v[52:67], v[148:151], a[44:47], v[52:67]
v_add_f32 v6, v6, v82
s_waitcnt vmcnt(15)
v_mfma_f32_32x32x16_bf16 v[36:51], v[152:155], a[48:51], v[36:51]
v_add_f32 v7, v7, v83
s_add_u32 s46, s54, 8704
buffer_load_dwordx4 a[108:111], v143, s[32:35], s46 offen sc1
v_mfma_f32_32x32x16_bf16 v[52:67], v[156:159], a[48:51], v[52:67]
s_waitcnt lgkmcnt(4)
v_add_f32 v8, v8, v84
s_waitcnt vmcnt(15)
v_mfma_f32_32x32x16_bf16 v[36:51], v[160:163], a[52:55], v[36:51]
v_add_f32 v9, v9, v85
s_add_u32 s46, s54, 17408
buffer_load_dwordx4 a[112:115], v143, s[32:35], s46 offen sc1
v_mfma_f32_32x32x16_bf16 v[52:67], v[164:167], a[52:55], v[52:67]
v_add_f32 v10, v10, v86
s_waitcnt vmcnt(15)
v_mfma_f32_32x32x16_bf16 v[36:51], v[168:171], a[56:59], v[36:51]
v_add_f32 v11, v11, v87
s_add_u32 s46, s54, 26112
buffer_load_dwordx4 a[116:119], v143, s[32:35], s46 offen sc1
v_mfma_f32_32x32x16_bf16 v[52:67], v[172:175], a[56:59], v[52:67]
s_waitcnt lgkmcnt(3)
v_add_f32 v4, v4, v88
s_waitcnt vmcnt(15)
v_mfma_f32_32x32x16_bf16 v[36:51], v[176:179], a[60:63], v[36:51]
v_add_f32 v5, v5, v89
s_add_u32 s46, s54, 34816
buffer_load_dwordx4 a[120:123], v143, s[32:35], s46 offen sc1
v_mfma_f32_32x32x16_bf16 v[52:67], v[180:183], a[60:63], v[52:67]
v_add_f32 v6, v6, v90
s_waitcnt vmcnt(15)
v_mfma_f32_32x32x16_bf16 v[36:51], v[184:187], a[64:67], v[36:51]
v_add_f32 v7, v7, v91
s_add_u32 s46, s54, 43520
buffer_load_dwordx4 a[124:127], v143, s[32:35], s46 offen sc1
v_mfma_f32_32x32x16_bf16 v[52:67], v[188:191], a[64:67], v[52:67]
s_waitcnt lgkmcnt(2)
v_add_f32 v8, v8, v92
s_waitcnt vmcnt(15)
v_mfma_f32_32x32x16_bf16 v[36:51], v[192:195], a[68:71], v[36:51]
v_add_f32 v9, v9, v93
s_add_u32 s46, s54, 52224
buffer_load_dwordx4 a[128:131], v143, s[32:35], s46 offen sc1
v_mfma_f32_32x32x16_bf16 v[52:67], v[196:199], a[68:71], v[52:67]
v_add_f32 v10, v10, v94
s_waitcnt vmcnt(15)
v_mfma_f32_32x32x16_bf16 v[36:51], v[200:203], a[72:75], v[36:51]
v_add_f32 v11, v11, v95
s_add_u32 s46, s54, 60928
buffer_load_dwordx4 a[132:135], v143, s[32:35], s46 offen sc1
v_mfma_f32_32x32x16_bf16 v[52:67], v[204:207], a[72:75], v[52:67]
s_waitcnt lgkmcnt(1)
v_add_f32 v4, v4, v96
s_waitcnt vmcnt(15)
v_mfma_f32_32x32x16_bf16 v[36:51], v[208:211], a[76:79], v[36:51]
v_add_f32 v5, v5, v97
s_add_u32 s46, s54, 69632
buffer_load_dwordx4 a[136:139], v143, s[32:35], s46 offen sc1
v_mfma_f32_32x32x16_bf16 v[52:67], v[212:215], a[76:79], v[52:67]
v_add_f32 v6, v6, v98
s_waitcnt vmcnt(15)
v_mfma_f32_32x32x16_bf16 v[36:51], v[216:219], a[80:83], v[36:51]
v_add_f32 v7, v7, v99
s_add_u32 s46, s54, 78336
buffer_load_dwordx4 a[140:143], v143, s[32:35], s46 offen sc1
v_mfma_f32_32x32x16_bf16 v[52:67], v[220:223], a[80:83], v[52:67]
s_waitcnt lgkmcnt(0)
v_add_f32 v8, v8, v100
s_waitcnt vmcnt(15)
v_mfma_f32_32x32x16_bf16 v[36:51], v[224:227], a[84:87], v[36:51]
v_add_f32 v9, v9, v101
s_add_u32 s46, s54, 87040
buffer_load_dwordx4 a[144:147], v143, s[32:35], s46 offen sc1
v_mfma_f32_32x32x16_bf16 v[52:67], v[228:231], a[84:87], v[52:67]
v_add_f32 v10, v10, v102
s_waitcnt vmcnt(15)
v_mfma_f32_32x32x16_bf16 v[36:51], v[232:235], a[88:91], v[36:51]
v_add_f32 v11, v11, v103
s_add_u32 s46, s54, 95744
buffer_load_dwordx4 a[148:151], v143, s[32:35], s46 offen sc1
v_mfma_f32_32x32x16_bf16 v[52:67], v[236:239], a[88:91], v[52:67]
v_cvt_pk_bf16_f32 v68, v4, v5
s_waitcnt vmcnt(15)
v_mfma_f32_32x32x16_bf16 v[36:51], a[0:3], a[92:95], v[36:51]
v_cvt_pk_bf16_f32 v69, v6, v7
s_add_u32 s46, s54, 104448
buffer_load_dwordx4 a[152:155], v143, s[32:35], s46 offen sc1
v_mfma_f32_32x32x16_bf16 v[52:67], a[4:7], a[92:95], v[52:67]
v_cvt_pk_bf16_f32 v70, v8, v9
s_waitcnt vmcnt(15)
v_mfma_f32_32x32x16_bf16 v[36:51], a[8:11], a[96:99], v[36:51]
v_cvt_pk_bf16_f32 v71, v10, v11
s_add_u32 s46, s54, 113152
buffer_load_dwordx4 a[156:159], v143, s[32:35], s46 offen sc1
v_mfma_f32_32x32x16_bf16 v[52:67], a[12:15], a[96:99], v[52:67]
buffer_store_dwordx4 v[68:71], v105, s[28:31], s43 offen
s_waitcnt vmcnt(16)
v_mfma_f32_32x32x16_bf16 v[36:51], a[16:19], a[100:103], v[36:51]
s_add_u32 s46, s54, 121856
s_sub_u32 s46, s46, s93
buffer_load_dwordx4 a[24:27], v143, s[32:35], s46 offen sc1
v_mfma_f32_32x32x16_bf16 v[52:67], a[20:23], a[100:103], v[52:67]
s_waitcnt vmcnt(15)
v_mfma_f32_32x32x16_bf16 v[4:19], a[160:163], a[104:107], 0
s_add_u32 s46, s54, 130560
s_sub_u32 s46, s46, s93
buffer_load_dwordx4 a[28:31], v143, s[32:35], s46 offen sc1
v_mfma_f32_32x32x16_bf16 v[20:35], a[164:167], a[104:107], 0
s_waitcnt vmcnt(15)
v_mfma_f32_32x32x16_bf16 v[4:19], a[168:171], a[108:111], v[4:19]
ds_write_b128 v106, v[44:47] offset:24576
s_add_u32 s46, s54, 139264
s_sub_u32 s46, s46, s93
buffer_load_dwordx4 a[32:35], v143, s[32:35], s46 offen sc1
v_mfma_f32_32x32x16_bf16 v[20:35], a[172:175], a[108:111], v[20:35]
ds_write_b128 v106, v[48:51] offset:25600
s_waitcnt vmcnt(15)
v_mfma_f32_32x32x16_bf16 v[4:19], a[176:179], a[112:115], v[4:19]
ds_write_b128 v107, v[52:55] offset:24576
s_add_u32 s46, s54, 147968
s_sub_u32 s46, s46, s93
buffer_load_dwordx4 a[36:39], v143, s[32:35], s46 offen sc1
v_mfma_f32_32x32x16_bf16 v[20:35], a[180:183], a[112:115], v[20:35]
ds_write_b128 v107, v[56:59] offset:25600
s_waitcnt vmcnt(15)
v_mfma_f32_32x32x16_bf16 v[4:19], a[184:187], a[116:119], v[4:19]
ds_write_b128 v108, v[60:63] offset:24576
s_add_u32 s46, s54, 156672
s_sub_u32 s46, s46, s93
buffer_load_dwordx4 a[40:43], v143, s[32:35], s46 offen sc1
v_mfma_f32_32x32x16_bf16 v[20:35], a[188:191], a[116:119], v[20:35]
ds_write_b128 v108, v[64:67] offset:25600
s_waitcnt vmcnt(15)
v_mfma_f32_32x32x16_bf16 v[4:19], a[192:195], a[120:123], v[4:19]
v_lshlrev_b32 v112, 16, v72
v_and_b32 v113, 0xffff0000, v72
s_add_u32 s46, s54, 165376
s_sub_u32 s46, s46, s93
buffer_load_dwordx4 a[44:47], v143, s[32:35], s46 offen sc1
v_mfma_f32_32x32x16_bf16 v[20:35], a[196:199], a[120:123], v[20:35]
v_add_f32 v36, v36, v112
v_add_f32 v37, v37, v113
s_waitcnt vmcnt(15)
v_mfma_f32_32x32x16_bf16 v[4:19], a[200:203], a[124:127], v[4:19]
v_lshlrev_b32 v112, 16, v73
v_and_b32 v113, 0xffff0000, v73
s_add_u32 s46, s54, 174080
s_sub_u32 s46, s46, s93
buffer_load_dwordx4 a[48:51], v143, s[32:35], s46 offen sc1
v_mfma_f32_32x32x16_bf16 v[20:35], a[204:207], a[124:127], v[20:35]
v_add_f32 v38, v38, v112
v_add_f32 v39, v39, v113
s_waitcnt vmcnt(15)
v_mfma_f32_32x32x16_bf16 v[4:19], a[208:211], a[128:131], v[4:19]
v_lshlrev_b32 v112, 16, v74
v_and_b32 v113, 0xffff0000, v74
s_add_u32 s46, s54, 182784
s_sub_u32 s46, s46, s93
buffer_load_dwordx4 a[52:55], v143, s[32:35], s46 offen sc1
v_mfma_f32_32x32x16_bf16 v[20:35], a[212:215], a[128:131], v[20:35]
v_add_f32 v40, v40, v112
v_add_f32 v41, v41, v113
s_waitcnt vmcnt(15)
v_mfma_f32_32x32x16_bf16 v[4:19], a[216:219], a[132:135], v[4:19]
v_lshlrev_b32 v112, 16, v75
v_and_b32 v113, 0xffff0000, v75
s_add_u32 s46, s54, 191488
s_sub_u32 s46, s46, s93
buffer_load_dwordx4 a[56:59], v143, s[32:35], s46 offen sc1
v_mfma_f32_32x32x16_bf16 v[20:35], a[220:223], a[132:135], v[20:35]
v_add_f32 v42, v42, v112
v_add_f32 v43, v43, v113
s_waitcnt vmcnt(15)
v_mfma_f32_32x32x16_bf16 v[4:19], a[224:227], a[136:139], v[4:19]
s_waitcnt lgkmcnt(0)
s_barrier
s_add_u32 s46, s54, 200192
s_sub_u32 s46, s46, s93
buffer_load_dwordx4 a[60:63], v143, s[32:35], s46 offen sc1
v_mfma_f32_32x32x16_bf16 v[20:35], a[228:231], a[136:139], v[20:35]
ds_read_b128 v[80:83], v104 offset:24576
s_waitcnt vmcnt(15)
v_mfma_f32_32x32x16_bf16 v[4:19], a[232:235], a[140:143], v[4:19]
ds_read_b128 v[84:87], v104 offset:25600
s_add_u32 s46, s54, 208896
s_sub_u32 s46, s46, s93
buffer_load_dwordx4 a[64:67], v143, s[32:35], s46 offen sc1
v_mfma_f32_32x32x16_bf16 v[20:35], a[236:239], a[140:143], v[20:35]
ds_read_b128 v[88:91], v104 offset:26624
s_waitcnt vmcnt(15)
v_mfma_f32_32x32x16_bf16 v[4:19], a[240:243], a[144:147], v[4:19]
ds_read_b128 v[92:95], v104 offset:27648
s_add_u32 s46, s54, 217600
s_sub_u32 s46, s46, s93
buffer_load_dwordx4 a[68:71], v143, s[32:35], s46 offen sc1
v_mfma_f32_32x32x16_bf16 v[20:35], a[244:247], a[144:147], v[20:35]
ds_read_b128 v[96:99], v104 offset:28672
s_waitcnt vmcnt(15)
v_mfma_f32_32x32x16_bf16 v[4:19], a[248:251], a[148:151], v[4:19]
ds_read_b128 v[100:103], v104 offset:29696
s_add_u32 s46, s54, 226304
s_sub_u32 s46, s46, s93
buffer_load_dwordx4 a[72:75], v143, s[32:35], s46 offen sc1
v_mfma_f32_32x32x16_bf16 v[20:35], a[252:255], a[148:151], v[20:35]
s_waitcnt lgkmcnt(5)
v_add_f32 v36, v36, v80
s_waitcnt vmcnt(15)
v_mfma_f32_32x32x16_bf16 v[4:19], v[144:147], a[152:155], v[4:19]
v_add_f32 v37, v37, v81
v_mfma_f32_32x32x16_bf16 v[20:35], v[148:151], a[152:155], v[20:35]
v_add_f32 v38, v38, v82
s_waitcnt vmcnt(14)
v_mfma_f32_32x32x16_bf16 v[4:19], v[152:155], a[156:159], v[4:19]
v_add_f32 v39, v39, v83
v_mfma_f32_32x32x16_bf16 v[20:35], v[156:159], a[156:159], v[20:35]
s_waitcnt lgkmcnt(4)
v_add_f32 v40, v40, v84
s_waitcnt vmcnt(12)
v_mfma_f32_32x32x16_bf16 v[4:19], v[160:163], a[24:27], v[4:19]
v_add_f32 v41, v41, v85
v_mfma_f32_32x32x16_bf16 v[20:35], v[164:167], a[24:27], v[20:35]
v_add_f32 v42, v42, v86
s_waitcnt vmcnt(11)
v_mfma_f32_32x32x16_bf16 v[4:19], v[168:171], a[28:31], v[4:19]
v_add_f32 v43, v43, v87
v_mfma_f32_32x32x16_bf16 v[20:35], v[172:175], a[28:31], v[20:35]
s_waitcnt lgkmcnt(3)
v_add_f32 v36, v36, v88
s_waitcnt vmcnt(10)
v_mfma_f32_32x32x16_bf16 v[4:19], v[176:179], a[32:35], v[4:19]
v_add_f32 v37, v37, v89
v_mfma_f32_32x32x16_bf16 v[20:35], v[180:183], a[32:35], v[20:35]
v_add_f32 v38, v38, v90
s_waitcnt vmcnt(9)
v_mfma_f32_32x32x16_bf16 v[4:19], v[184:187], a[36:39], v[4:19]
v_add_f32 v39, v39, v91
v_mfma_f32_32x32x16_bf16 v[20:35], v[188:191], a[36:39], v[20:35]
s_waitcnt lgkmcnt(2)
v_add_f32 v40, v40, v92
s_waitcnt vmcnt(8)
v_mfma_f32_32x32x16_bf16 v[4:19], v[192:195], a[40:43], v[4:19]
v_add_f32 v41, v41, v93
v_mfma_f32_32x32x16_bf16 v[20:35], v[196:199], a[40:43], v[20:35]
v_add_f32 v42, v42, v94
s_waitcnt vmcnt(7)
v_mfma_f32_32x32x16_bf16 v[4:19], v[200:203], a[44:47], v[4:19]
v_add_f32 v43, v43, v95
v_mfma_f32_32x32x16_bf16 v[20:35], v[204:207], a[44:47], v[20:35]
s_waitcnt lgkmcnt(1)
v_add_f32 v36, v36, v96
s_waitcnt vmcnt(6)
v_mfma_f32_32x32x16_bf16 v[4:19], v[208:211], a[48:51], v[4:19]
v_add_f32 v37, v37, v97
v_mfma_f32_32x32x16_bf16 v[20:35], v[212:215], a[48:51], v[20:35]
v_add_f32 v38, v38, v98
s_waitcnt vmcnt(5)
v_mfma_f32_32x32x16_bf16 v[4:19], v[216:219], a[52:55], v[4:19]
v_add_f32 v39, v39, v99
v_mfma_f32_32x32x16_bf16 v[20:35], v[220:223], a[52:55], v[20:35]
s_waitcnt lgkmcnt(0)
v_add_f32 v40, v40, v100
s_waitcnt vmcnt(4)
v_mfma_f32_32x32x16_bf16 v[4:19], v[224:227], a[56:59], v[4:19]
v_add_f32 v41, v41, v101
v_mfma_f32_32x32x16_bf16 v[20:35], v[228:231], a[56:59], v[20:35]
v_add_f32 v42, v42, v102
s_waitcnt vmcnt(3)
v_mfma_f32_32x32x16_bf16 v[4:19], v[232:235], a[60:63], v[4:19]
v_add_f32 v43, v43, v103
v_mfma_f32_32x32x16_bf16 v[20:35], v[236:239], a[60:63], v[20:35]
v_cvt_pk_bf16_f32 v72, v36, v37
s_waitcnt vmcnt(2)
v_mfma_f32_32x32x16_bf16 v[4:19], a[0:3], a[64:67], v[4:19]
v_cvt_pk_bf16_f32 v73, v38, v39
v_mfma_f32_32x32x16_bf16 v[20:35], a[4:7], a[64:67], v[20:35]
v_cvt_pk_bf16_f32 v74, v40, v41
s_waitcnt vmcnt(1)
v_mfma_f32_32x32x16_bf16 v[4:19], a[8:11], a[68:71], v[4:19]
v_cvt_pk_bf16_f32 v75, v42, v43
v_mfma_f32_32x32x16_bf16 v[20:35], a[12:15], a[68:71], v[20:35]
buffer_store_dwordx4 v[72:75], v105, s[28:31], s44 offen
s_waitcnt vmcnt(1)
v_mfma_f32_32x32x16_bf16 v[4:19], a[16:19], a[72:75], v[4:19]
v_mfma_f32_32x32x16_bf16 v[20:35], a[20:23], a[72:75], v[20:35]
s_nop 10
ds_write_b128 v106, v[12:15] offset:49152
ds_write_b128 v106, v[16:19] offset:50176
ds_write_b128 v107, v[20:23] offset:49152
ds_write_b128 v107, v[24:27] offset:50176
ds_write_b128 v108, v[28:31] offset:49152
ds_write_b128 v108, v[32:35] offset:50176
v_lshlrev_b32 v112, 16, v76
v_and_b32 v113, 0xffff0000, v76
v_pk_add_f32 v[4:5], v[4:5], v[112:113]
v_lshlrev_b32 v112, 16, v77
v_and_b32 v113, 0xffff0000, v77
v_pk_add_f32 v[6:7], v[6:7], v[112:113]
v_lshlrev_b32 v112, 16, v78
v_and_b32 v113, 0xffff0000, v78
v_pk_add_f32 v[8:9], v[8:9], v[112:113]
v_lshlrev_b32 v112, 16, v79
v_and_b32 v113, 0xffff0000, v79
v_pk_add_f32 v[10:11], v[10:11], v[112:113]
s_waitcnt lgkmcnt(0)
s_barrier
ds_read_b128 v[80:83], v104 offset:49152
ds_read_b128 v[84:87], v104 offset:50176
ds_read_b128 v[88:91], v104 offset:51200
ds_read_b128 v[92:95], v104 offset:52224
ds_read_b128 v[96:99], v104 offset:53248
ds_read_b128 v[100:103], v104 offset:54272
s_waitcnt lgkmcnt(5)
v_pk_add_f32 v[4:5], v[4:5], v[80:81]
v_pk_add_f32 v[6:7], v[6:7], v[82:83]
s_waitcnt lgkmcnt(4)
v_pk_add_f32 v[8:9], v[8:9], v[84:85]
v_pk_add_f32 v[10:11], v[10:11], v[86:87]
s_waitcnt lgkmcnt(3)
v_pk_add_f32 v[4:5], v[4:5], v[88:89]
v_pk_add_f32 v[6:7], v[6:7], v[90:91]
s_waitcnt lgkmcnt(2)
v_pk_add_f32 v[8:9], v[8:9], v[92:93]
v_pk_add_f32 v[10:11], v[10:11], v[94:95]
s_waitcnt lgkmcnt(1)
v_pk_add_f32 v[4:5], v[4:5], v[96:97]
v_pk_add_f32 v[6:7], v[6:7], v[98:99]
s_waitcnt lgkmcnt(0)
v_pk_add_f32 v[8:9], v[8:9], v[100:101]
v_pk_add_f32 v[10:11], v[10:11], v[102:103]
v_cvt_pk_bf16_f32 v76, v4, v5
v_cvt_pk_bf16_f32 v77, v6, v7
v_cvt_pk_bf16_f32 v78, v8, v9
v_cvt_pk_bf16_f32 v79, v10, v11
buffer_store_dwordx4 v[76:79], v105, s[28:31], s45 offen
s_branch Lfin0
Lwb:
v_lshlrev_b32 v25, 7, v0
s_sub_u32 s42, s5, 30
s_lshl_b32 s42, s42, 2
s_add_u32 s42, s42, s6
s_lshl_b32 s42, s42, 13
s_add_u32 s42, s42, 1044480
s_add_u32 s3, s42, 0
buffer_load_dword v50, v25, s[32:35], s3 offen
s_add_u32 s3, s42, 65536
buffer_load_dword v51, v25, s[32:35], s3 offen
s_add_u32 s3, s42, 131072
buffer_load_dword v52, v25, s[32:35], s3 offen
s_add_u32 s3, s42, 196608
buffer_load_dword v53, v25, s[32:35], s3 offen
s_cmp_lg_u32 s5, 31
s_cbranch_scc1 Lfin0
s_cmp_lg_u32 s6, 0
s_cbranch_scc1 Lfin0
s_mov_b32 s92, -1
s_mov_b32 s90, 1
s_cmp_lg_u32 s6, 0
s_cbranch_scc1 La_57
s_mov_b32 s3, 1736960
v_lshlrev_b32 v254, 2, v0
s_mov_b32 exec_lo, s92
s_mov_b32 exec_hi, 0
Lap_58:
s_sub_u32 s91, s91, 1
s_cbranch_scc1 Lend
buffer_load_dword v255, v254, s[32:35], s3 offen sc1
Lac_59:
s_waitcnt vmcnt(0)
s_waitcnt vmcnt(0)
v_cmp_ne_u32 vcc, s7, v255
s_cbranch_vccnz Lap_58
s_mov_b64 exec, -1
s_cmp_lg_u32 s90, 0
s_cbranch_scc1 La_57
buffer_inv sc1
s_waitcnt vmcnt(0)
La_57:
s_mov_b32 s3, 1736704
s_mov_b64 exec, 1
buffer_store_dword v255, v254, s[32:35], s3 offen sc1
s_mov_b64 exec, -1
Lfin0:
s_waitcnt vmcnt(0)
Lfin:
Lend:
s_endpgm
Lendcode:
.section .rodata,"a"
.p2align 6
.amdhsa_kernel sequential_preLN__sliding_local_dilated__dense_activation_silu__prompt_kernel
  .amdhsa_next_free_vgpr 512
  .amdhsa_next_free_sgpr 102
  .amdhsa_accum_offset 256
  .amdhsa_group_segment_fixed_size 0
  .amdhsa_kernarg_size 72
  .amdhsa_user_sgpr_count 2
  .amdhsa_user_sgpr_kernarg_segment_ptr 1
  .amdhsa_system_sgpr_workgroup_id_x 1
.end_amdhsa_kernel
```
